```python
import torch

def _softmax(x, axis=-1):
    return torch.softmax(x, dim=axis)
def _gelu(x):
    return torch.nn.functional.gelu(x, approximate="tanh")
def _silu(x):
    return torch.nn.functional.silu(x)
def _sigmoid(x):
    return torch.sigmoid(x)
def _layernorm(x, axis=-1, eps=1e-5):
    m = x.mean(dim=axis, keepdim=True)
    v = x.var(dim=axis, keepdim=True, unbiased=False)
    return (x - m) / torch.sqrt(v + eps)
def _scatter_add(tgt, idx, src, axis=0):
    return tgt.clone().index_add_(axis, idx, src)
def _segment_sum(src, seg, n):
    out = torch.zeros((n,) + src.shape[1:], dtype=src.dtype)
    return out.index_add_(0, seg, src)
def _pad(x, pw):
    flat = tuple(v for pair in reversed(pw) for v in pair)
    return torch.nn.functional.pad(x, flat)

kernel_name = 'recurrent_scan__gqa_block_cached__dense_activation_relu__decode'

def setup_inputs():

    _w = (lambda a: (lambda t: t.to(torch.bfloat16) if t.is_floating_point() else t)(torch.as_tensor(a)))
    def _A_setup():
        B, Sq, D = 1, 1, 512
        Hq, Hkv, Sk, Dh = 32, 8, 65536, 128
        assert Hq % Hkv == 0, (Hq, Hkv)
        return {
            "x": _w((lambda *s: torch.randn(*s, dtype=torch.bfloat16) * 0.05)(B, Sq, D)),
            "k_cache": _w((lambda *s: torch.randn(*s, dtype=torch.bfloat16) * 0.8)(B, Hkv, Sk, Dh)),
            "v_cache": _w((lambda *s: torch.randn(*s, dtype=torch.bfloat16) * 0.8)(B, Hkv, Sk, Dh)),
            "wq": _w((lambda *s: torch.randn(*s, dtype=torch.bfloat16) * 0.8)(D, Hq * Dh) * (D ** -0.5)),
            "wo": _w((lambda *s: torch.randn(*s, dtype=torch.bfloat16) * 0.8)(Hq * Dh, D) * ((Hq * Dh) ** -0.5)),
        }
    _A_in = _A_setup()

    def _B_setup():
        B, S, D, Dff = 1, 1, 512, 1792
        return {
            "x": _w((lambda *s: torch.randn(*s, dtype=torch.bfloat16) * 0.05)(B, S, D)),
            "w1": _w((lambda *s: torch.randn(*s, dtype=torch.bfloat16) * 0.2)(D, Dff)),
            "w2": _w((lambda *s: torch.randn(*s, dtype=torch.bfloat16) * 0.2)(Dff, D)),
        }
    _B_in = _B_setup()

    return {
        "A_x": _A_in["x"],
        "A_k_cache": _A_in["k_cache"],
        "A_v_cache": _A_in["v_cache"],
        "A_wq": _A_in["wq"],
        "A_wo": _A_in["wo"],
        "B_x": _B_in["x"],
        "B_w1": _B_in["w1"],
        "B_w2": _B_in["w2"],
    }

def reference(A_x, A_k_cache, A_v_cache, A_wq, A_wo, B_x, B_w1, B_w2):
    def _A_ref(x, k_cache, v_cache, wq, wo):
        B, Sq, D = x.shape
        Hq, Dh = 32, 128
        Hkv = k_cache.shape[1]
        rep = Hq // Hkv
        q = (lambda x, *d: x.permute(*d))((x @ wq).reshape(B, Sq, Hq, Dh), 0, 2, 1, 3)
        k = (lambda x, n, axis: torch.repeat_interleave(x, n, dim=axis))(k_cache, rep, axis=1)
        v = (lambda x, n, axis: torch.repeat_interleave(x, n, dim=axis))(v_cache, rep, axis=1)
        scores = torch.einsum("bhqd,bhkd->bhqk", q, k) * (Dh ** -0.5)
        p = _softmax(scores, axis=-1)
        o = torch.einsum("bhqk,bhkd->bhqd", p, v)
        return (lambda x, *d: x.permute(*d))(o, 0, 2, 1, 3).reshape(B, Sq, Hq * Dh) @ wo

    def _B_ref(x, w1, w2):
        h = torch.einsum("bsd,df->bsf", x, w1)
        zero = torch.zeros_like(h)
        h = torch.maximum(h, zero)
        return torch.einsum("bsf,fd->bsd", h, w2)

    x = A_x
    xn = _layernorm(x, axis=-1)
    s = _A_ref(xn, A_k_cache, A_v_cache, A_wq, A_wo)
    g = _silu(_B_ref(xn, B_w1, B_w2))
    return x + s * g
```

```asm
; @launch grid=(256,1,1) block=(320,1,1) lds=10496
.amdgcn_target "amdgcn-amd-amdhsa--gfx950"
.text
.p2align 12
.globl recurrent_scan__gqa_block_cached__dense_activation_relu__decode_kernel
.p2align 8
.type recurrent_scan__gqa_block_cached__dense_activation_relu__decode_kernel,@function
recurrent_scan__gqa_block_cached__dense_activation_relu__decode_kernel:
    s_cmp_ge_u32 s2, 256
    s_cbranch_scc1 L_end
    s_load_dwordx16 s[4:19], s[0:1], 0
    s_load_dwordx2 s[24:25], s[0:1], 80
    s_load_dwordx2 s[20:21], s[0:1], 64
    v_lshrrev_b32 v1, 6, v0
    v_and_b32 v0, 63, v0
    v_readfirstlane_b32 s3, v1
    s_lshr_b32 s26, s2, 5
    s_and_b32 s27, s2, 31
    s_and_b32 s22, s2, 7
    s_lshr_b32 s40, s27, 3
    s_lshl2_add_u32 s22, s22, s40
    s_cmp_lg_u32 s3, 0
    s_cbranch_scc1 L_stream
    s_memrealtime s[86:87]
    v_lshrrev_b32 v4, 1, v0
    v_lshlrev_b32 v2, 5, v4
    v_and_b32 v5, 1, v0
    v_lshlrev_b32 v5, 4, v5
    v_lshl_or_b32 v3, v4, 17, v5
    s_lshl_b32 s40, s26, 10
    s_lshl_b32 s41, s22, 5
    s_add_u32 s40, s40, s41
    s_sub_u32 s34, 0x400000, s40
    s_mov_b32 s35, 0x20000
    s_movk_i32 s30, 1024
    s_mov_b32 s31, 0x20000
    s_mov_b32 s38, 0x800000
    s_mov_b32 s39, 0x20000
    s_waitcnt lgkmcnt(0)
    s_mov_b32 s28, s4
    s_mov_b32 s29, s5
    s_add_u32 s36, s24, 0x1f800000
    s_addc_u32 s37, s25, 0
    buffer_load_dwordx4 v[8:11], v2, s[28:31], 0 offen
    buffer_load_dwordx4 v[12:15], v2, s[28:31], 0 offen offset:16
    s_load_dword s23, s[36:37], 0
    s_add_u32 s32, s10, s40
    s_addc_u32 s33, s11, 0
    s_mov_b32 s47, 0
    buffer_load_dwordx4 v[64:67], v3, s[32:35], s47 offen nt
    s_addk_i32 s47, 8192
    buffer_load_dwordx4 v[68:71], v3, s[32:35], s47 offen nt
    s_addk_i32 s47, 8192
    buffer_load_dwordx4 v[72:75], v3, s[32:35], s47 offen nt
    s_addk_i32 s47, 8192
    buffer_load_dwordx4 v[76:79], v3, s[32:35], s47 offen nt
    s_addk_i32 s47, 8192
    buffer_load_dwordx4 v[80:83], v3, s[32:35], s47 offen nt
    s_addk_i32 s47, 8192
    buffer_load_dwordx4 v[84:87], v3, s[32:35], s47 offen nt
    s_addk_i32 s47, 8192
    buffer_load_dwordx4 v[88:91], v3, s[32:35], s47 offen nt
    s_addk_i32 s47, 8192
    buffer_load_dwordx4 v[92:95], v3, s[32:35], s47 offen nt
    s_addk_i32 s47, 8192
    buffer_load_dwordx4 v[96:99], v3, s[32:35], s47 offen nt
    s_addk_i32 s47, 8192
    buffer_load_dwordx4 v[100:103], v3, s[32:35], s47 offen nt
    s_addk_i32 s47, 8192
    buffer_load_dwordx4 v[104:107], v3, s[32:35], s47 offen nt
    s_addk_i32 s47, 8192
    buffer_load_dwordx4 v[108:111], v3, s[32:35], s47 offen nt
    s_addk_i32 s47, 8192
    buffer_load_dwordx4 v[112:115], v3, s[32:35], s47 offen nt
    s_addk_i32 s47, 8192
    buffer_load_dwordx4 v[116:119], v3, s[32:35], s47 offen nt
    s_addk_i32 s47, 8192
    buffer_load_dwordx4 v[120:123], v3, s[32:35], s47 offen nt
    s_addk_i32 s47, 8192
    buffer_load_dwordx4 v[124:127], v3, s[32:35], s47 offen nt
    s_barrier
    s_branch L_service
L_stream:
    s_sub_u32 s3, s3, 1
    v_and_b32 v4, 15, v0
    v_lshrrev_b32 v5, 4, v0
    v_lshlrev_b32 v2, 4, v5
    v_lshl_or_b32 v2, v4, 8, v2
    v_lshlrev_b32 v3, 4, v4
    v_lshl_or_b32 v3, v5, 10, v3
    s_lshl_b32 s40, s26, 24
    s_mul_i32 s51, s27, 124
    s_movk_i32 s54, 124
    s_cmp_lt_u32 s27, 14
    s_cbranch_scc1 L_rng
    s_sub_u32 s41, s27, 14
    s_mul_i32 s51, s41, 131
    s_min_u32 s54, s41, 2
    s_add_u32 s51, s51, s54
    s_add_u32 s51, s51, 1736
    s_cmp_lt_u32 s41, 2
    s_addc_u32 s54, 131, 0
L_rng:
    s_lshl_b32 s51, s51, 12
    s_lshl_b32 s41, s3, 12
    s_add_u32 s41, s41, s51
    s_waitcnt lgkmcnt(0)
    s_add_u32 s28, s6, s40
    s_addc_u32 s29, s7, 0
    s_mov_b32 s30, 0x1000000
    s_mov_b32 s31, 0x20000
    s_add_u32 s32, s8, s40
    s_addc_u32 s33, s9, 0
    s_mov_b32 s34, 0x1000000
    s_mov_b32 s35, 0x20000
    s_barrier
    buffer_load_dwordx4 v[64:67], v2, s[28:31], s41 offen offset:0 nt
    buffer_load_dwordx4 v[68:71], v2, s[28:31], s41 offen offset:64 nt
    buffer_load_dwordx4 v[72:75], v2, s[28:31], s41 offen offset:128 nt
    buffer_load_dwordx4 v[76:79], v2, s[28:31], s41 offen offset:192 nt
    buffer_load_dwordx4 v[80:83], v3, s[32:35], s41 offen offset:0 nt
    buffer_load_dwordx4 v[84:87], v3, s[32:35], s41 offen offset:256 nt
    buffer_load_dwordx4 v[88:91], v3, s[32:35], s41 offen offset:512 nt
    buffer_load_dwordx4 v[92:95], v3, s[32:35], s41 offen offset:768 nt
    s_addk_i32 s41, 16384
    buffer_load_dwordx4 v[96:99], v2, s[28:31], s41 offen offset:0 nt
    buffer_load_dwordx4 v[100:103], v2, s[28:31], s41 offen offset:64 nt
    buffer_load_dwordx4 v[104:107], v2, s[28:31], s41 offen offset:128 nt
    buffer_load_dwordx4 v[108:111], v2, s[28:31], s41 offen offset:192 nt
    buffer_load_dwordx4 v[112:115], v3, s[32:35], s41 offen offset:0 nt
    buffer_load_dwordx4 v[116:119], v3, s[32:35], s41 offen offset:256 nt
    buffer_load_dwordx4 v[120:123], v3, s[32:35], s41 offen offset:512 nt
    buffer_load_dwordx4 v[124:127], v3, s[32:35], s41 offen offset:768 nt
    s_addk_i32 s41, 16384
    s_add_u32 s36, s24, 0x1f800000
    s_addc_u32 s37, s25, 0
    s_mov_b32 s38, 0x800000
    s_mov_b32 s39, 0x20000
    s_mov_b32 s53, 0x1000000
    v_mov_b32 v13, 1028
    v_mov_b32 v14, 1
    s_sub_u32 s55, s54, 16
    s_mov_b32 s56, 0
    s_mov_b32 s48, 0
    s_mov_b32 s49, 0
    v_and_b32 v6, 1, v0
    v_lshlrev_b32 v6, 4, v6
    v_mov_b32 v47, 0xffff
    v_lshlrev_b32 v47, v6, v47
    v_bfe_i32 v6, v0, 1, 1
    v_and_b32 v48, v47, v6
    v_xor_b32 v47, v47, v48
    v_lshrrev_b32 v4, 2, v4
    v_lshlrev_b32 v6, 4, v5
    v_lshl_or_b32 v6, v4, 8, v6
    v_mov_b32 v36, 0
    v_mov_b32 v37, 0
    v_mov_b32 v38, 0
    v_mov_b32 v39, 0
    v_mov_b32 v40, 0
    v_mov_b32 v41, 0
    v_mov_b32 v42, 0
    v_mov_b32 v43, 0
    v_mov_b32 v44, 0xff800000
    v_mov_b32 v45, 0
    v_mov_b32 v46, 0
    s_mov_b32 s44, 0x3e0293ee
    s_mov_b32 s42, 0
    v_mul_u32_u24 v8, 528, v4
    v_lshlrev_b32 v9, 7, v5
    v_add_u32 v8, v8, v9
    v_and_b32 v9, 3, v0
    v_lshl_add_u32 v8, v9, 2, v8
    s_mul_i32 s45, s3, 2112
    s_add_u32 s45, s45, 2048
    v_add_u32 v8, s45, v8
    s_lshl_b32 s45, s3, 2
    s_add_u32 s45, s45, 1088
    v_lshlrev_b32 v9, 5, v4
    v_add_u32 v9, s45, v9
    s_lshl_b32 s45, s3, 5
    s_add_u32 s45, s45, 1088
    v_mov_b32 v10, s45
    s_mul_i32 s45, s3, 528
    s_add_u32 s45, s45, 2048
    v_lshlrev_b32 v11, 3, v0
    v_add_u32 v11, s45, v11
    v_lshrrev_b32 v12, 3, v0
    v_lshlrev_b32 v12, 12, v12
    v_and_b32 v1, 7, v0
    v_lshl_add_u32 v12, v1, 4, v12
    s_lshl_b32 s45, s26, 17
    s_lshl_b32 s46, s3, 15
    s_add_u32 s45, s45, s46
    s_lshl_b32 s46, s27, 7
    s_add_u32 s45, s45, s46
    s_add_u32 s45, s45, 1048576
    s_lshl_b32 s46, s26, 11
    s_lshl_b32 s47, s3, 9
    s_add_u32 s46, s46, s47
    s_lshl_b32 s47, s27, 4
    s_add_u32 s46, s46, s47
    s_add_u32 s46, s46, 32768
    s_waitcnt vmcnt(8)
    buffer_load_dwordx4 v[128:131], v2, s[28:31], s41 offen offset:0 nt
    buffer_load_dwordx4 v[132:135], v2, s[28:31], s41 offen offset:64 nt
    buffer_load_dwordx4 v[136:139], v2, s[28:31], s41 offen offset:128 nt
    buffer_load_dwordx4 v[140:143], v2, s[28:31], s41 offen offset:192 nt
    buffer_load_dwordx4 v[144:147], v3, s[32:35], s41 offen offset:0 nt
    buffer_load_dwordx4 v[148:151], v3, s[32:35], s41 offen offset:256 nt
    buffer_load_dwordx4 v[152:155], v3, s[32:35], s41 offen offset:512 nt
    buffer_load_dwordx4 v[156:159], v3, s[32:35], s41 offen offset:768 nt
    s_addk_i32 s41, 16384
    s_waitcnt vmcnt(8)
    buffer_load_dwordx4 v[160:163], v2, s[28:31], s41 offen offset:0 nt
    buffer_load_dwordx4 v[164:167], v2, s[28:31], s41 offen offset:64 nt
    buffer_load_dwordx4 v[168:171], v2, s[28:31], s41 offen offset:128 nt
    buffer_load_dwordx4 v[172:175], v2, s[28:31], s41 offen offset:192 nt
    buffer_load_dwordx4 v[176:179], v3, s[32:35], s41 offen offset:0 nt
    buffer_load_dwordx4 v[180:183], v3, s[32:35], s41 offen offset:256 nt
    buffer_load_dwordx4 v[184:187], v3, s[32:35], s41 offen offset:512 nt
    buffer_load_dwordx4 v[188:191], v3, s[32:35], s41 offen offset:768 nt
    s_addk_i32 s41, 16384
    s_waitcnt vmcnt(8)
    buffer_load_dwordx4 v[192:195], v2, s[28:31], s41 offen offset:0 nt
    buffer_load_dwordx4 v[196:199], v2, s[28:31], s41 offen offset:64 nt
    buffer_load_dwordx4 v[200:203], v2, s[28:31], s41 offen offset:128 nt
    buffer_load_dwordx4 v[204:207], v2, s[28:31], s41 offen offset:192 nt
    buffer_load_dwordx4 v[208:211], v3, s[32:35], s41 offen offset:0 nt
    buffer_load_dwordx4 v[212:215], v3, s[32:35], s41 offen offset:256 nt
    buffer_load_dwordx4 v[216:219], v3, s[32:35], s41 offen offset:512 nt
    buffer_load_dwordx4 v[220:223], v3, s[32:35], s41 offen offset:768 nt
    s_addk_i32 s41, 16384
    s_waitcnt vmcnt(8)
    buffer_load_dwordx4 v[224:227], v2, s[28:31], s41 offen offset:0 nt
    buffer_load_dwordx4 v[228:231], v2, s[28:31], s41 offen offset:64 nt
    buffer_load_dwordx4 v[232:235], v2, s[28:31], s41 offen offset:128 nt
    buffer_load_dwordx4 v[236:239], v2, s[28:31], s41 offen offset:192 nt
    buffer_load_dwordx4 v[240:243], v3, s[32:35], s41 offen offset:0 nt
    buffer_load_dwordx4 v[244:247], v3, s[32:35], s41 offen offset:256 nt
    buffer_load_dwordx4 v[248:251], v3, s[32:35], s41 offen offset:512 nt
    buffer_load_dwordx4 v[252:255], v3, s[32:35], s41 offen offset:768 nt
    s_addk_i32 s41, 16384
    s_barrier
    ds_read_b128 v[16:19], v6 offset:0
    ds_read_b128 v[20:23], v6 offset:64
    ds_read_b128 v[24:27], v6 offset:128
    ds_read_b128 v[28:31], v6 offset:192
    v_mov_b32 v7, 0
    ds_read_b32 v7, v7 offset:1024
    s_waitcnt lgkmcnt(0)
L_loop:
    s_cmp_ge_u32 s48, s53
    s_cbranch_scc1 L_sdone
    s_waitcnt vmcnt(12)
    s_mov_b64 exec, 1
    ds_add_rtn_u32 v15, v13, v14
    s_mov_b64 exec, -1
    v_mfma_f32_16x16x32_bf16 v[32:35], v[192:195], v[16:19], 0
    v_mfma_f32_16x16x32_bf16 v[32:35], v[196:199], v[20:23], v[32:35]
    v_mfma_f32_16x16x32_bf16 v[32:35], v[200:203], v[24:27], v[32:35]
    v_mfma_f32_16x16x32_bf16 v[32:35], v[204:207], v[28:31], v[32:35]
    s_add_u32 s42, s42, 1
    s_waitcnt lgkmcnt(0)
    v_readfirstlane_b32 s52, v15
    s_cmp_ge_u32 s52, s55
    s_cbranch_scc1 L_sw4
    s_lshl_b32 s48, s52, 12
    s_add_u32 s48, s48, s51
L_swr4:
    buffer_load_dwordx4 v[192:195], v2, s[28:31], s48 offen offset:0 nt
    buffer_load_dwordx4 v[196:199], v2, s[28:31], s48 offen offset:64 nt
    buffer_load_dwordx4 v[200:203], v2, s[28:31], s48 offen offset:128 nt
    buffer_load_dwordx4 v[204:207], v2, s[28:31], s48 offen offset:192 nt
    v_max3_f32 v49, v32, v33, v34
    v_max_f32 v49, v49, v35
    v_cmp_gt_f32 vcc, v49, v44
    s_cbranch_vccz L_skip4
    v_mov_b32 v50, v49
    s_nop 1
    v_permlane32_swap_b32 v50, v49
    v_max_f32 v49, v49, v50
    v_mov_b32 v50, v49
    s_nop 1
    v_permlane16_swap_b32 v50, v49
    v_max_f32 v49, v49, v50
    v_max_f32 v49, v49, v44
    v_sub_f32 v50, v44, v49
    v_mul_f32 v50, s44, v50
    v_exp_f32 v50, v50
    v_mov_b32 v44, v49
    v_mul_f32 v45, s44, v49
    v_mul_f32 v46, v46, v50
    v_mul_f32 v36, v36, v50
    v_mul_f32 v37, v37, v50
    v_mul_f32 v38, v38, v50
    v_mul_f32 v39, v39, v50
    v_mul_f32 v40, v40, v50
    v_mul_f32 v41, v41, v50
    v_mul_f32 v42, v42, v50
    v_mul_f32 v43, v43, v50
L_skip4:
    v_fma_f32 v32, v32, s44, -v45
    v_fma_f32 v33, v33, s44, -v45
    v_fma_f32 v34, v34, s44, -v45
    v_fma_f32 v35, v35, s44, -v45
    v_exp_f32 v32, v32
    v_exp_f32 v33, v33
    v_exp_f32 v34, v34
    v_exp_f32 v35, v35
    v_cvt_pk_bf16_f32 v49, v32, v32
    v_cvt_pk_bf16_f32 v50, v33, v33
    v_cvt_pk_bf16_f32 v51, v34, v34
    v_cvt_pk_bf16_f32 v52, v35, v35
    v_and_b32 v54, v49, v47
    v_and_b32 v55, v49, v48
    v_and_b32 v56, v50, v47
    v_and_b32 v57, v50, v48
    v_and_b32 v58, v51, v47
    v_and_b32 v59, v51, v48
    v_and_b32 v60, v52, v47
    v_and_b32 v61, v52, v48
    v_add_f32 v32, v32, v33
    v_add_f32 v34, v34, v35
    s_waitcnt vmcnt(12)
    v_mfma_f32_16x16x16_bf16 v[36:39], v[208:209], v[54:55], v[36:39]
    v_mfma_f32_16x16x16_bf16 v[40:43], v[210:211], v[54:55], v[40:43]
    v_add_f32 v46, v46, v32
    v_mfma_f32_16x16x16_bf16 v[36:39], v[212:213], v[56:57], v[36:39]
    v_mfma_f32_16x16x16_bf16 v[40:43], v[214:215], v[56:57], v[40:43]
    v_add_f32 v46, v46, v34
    v_mfma_f32_16x16x16_bf16 v[36:39], v[216:217], v[58:59], v[36:39]
    v_mfma_f32_16x16x16_bf16 v[40:43], v[218:219], v[58:59], v[40:43]
    v_mfma_f32_16x16x16_bf16 v[36:39], v[220:221], v[60:61], v[36:39]
    v_mfma_f32_16x16x16_bf16 v[40:43], v[222:223], v[60:61], v[40:43]
    buffer_load_dwordx4 v[208:211], v3, s[32:35], s48 offen offset:0 nt
    buffer_load_dwordx4 v[212:215], v3, s[32:35], s48 offen offset:256 nt
    buffer_load_dwordx4 v[216:219], v3, s[32:35], s48 offen offset:512 nt
    buffer_load_dwordx4 v[220:223], v3, s[32:35], s48 offen offset:768 nt
    s_cmp_eq_u32 s42, 1
    s_cbranch_scc1 L_backlog
L_resume:
    s_cmp_ge_u32 s49, s53
    s_cbranch_scc1 L_sdone
    s_waitcnt vmcnt(12)
    s_mov_b64 exec, 1
    ds_add_rtn_u32 v15, v13, v14
    s_mov_b64 exec, -1
    v_mfma_f32_16x16x32_bf16 v[32:35], v[224:227], v[16:19], 0
    v_mfma_f32_16x16x32_bf16 v[32:35], v[228:231], v[20:23], v[32:35]
    v_mfma_f32_16x16x32_bf16 v[32:35], v[232:235], v[24:27], v[32:35]
    v_mfma_f32_16x16x32_bf16 v[32:35], v[236:239], v[28:31], v[32:35]
    s_add_u32 s42, s42, 1
    s_waitcnt lgkmcnt(0)
    v_readfirstlane_b32 s52, v15
    s_cmp_ge_u32 s52, s55
    s_cbranch_scc1 L_sw5
    s_lshl_b32 s49, s52, 12
    s_add_u32 s49, s49, s51
L_swr5:
    buffer_load_dwordx4 v[224:227], v2, s[28:31], s49 offen offset:0 nt
    buffer_load_dwordx4 v[228:231], v2, s[28:31], s49 offen offset:64 nt
    buffer_load_dwordx4 v[232:235], v2, s[28:31], s49 offen offset:128 nt
    buffer_load_dwordx4 v[236:239], v2, s[28:31], s49 offen offset:192 nt
    v_max3_f32 v49, v32, v33, v34
    v_max_f32 v49, v49, v35
    v_cmp_gt_f32 vcc, v49, v44
    s_cbranch_vccz L_skip5
    v_mov_b32 v50, v49
    s_nop 1
    v_permlane32_swap_b32 v50, v49
    v_max_f32 v49, v49, v50
    v_mov_b32 v50, v49
    s_nop 1
    v_permlane16_swap_b32 v50, v49
    v_max_f32 v49, v49, v50
    v_max_f32 v49, v49, v44
    v_sub_f32 v50, v44, v49
    v_mul_f32 v50, s44, v50
    v_exp_f32 v50, v50
    v_mov_b32 v44, v49
    v_mul_f32 v45, s44, v49
    v_mul_f32 v46, v46, v50
    v_mul_f32 v36, v36, v50
    v_mul_f32 v37, v37, v50
    v_mul_f32 v38, v38, v50
    v_mul_f32 v39, v39, v50
    v_mul_f32 v40, v40, v50
    v_mul_f32 v41, v41, v50
    v_mul_f32 v42, v42, v50
    v_mul_f32 v43, v43, v50
L_skip5:
    v_fma_f32 v32, v32, s44, -v45
    v_fma_f32 v33, v33, s44, -v45
    v_fma_f32 v34, v34, s44, -v45
    v_fma_f32 v35, v35, s44, -v45
    v_exp_f32 v32, v32
    v_exp_f32 v33, v33
    v_exp_f32 v34, v34
    v_exp_f32 v35, v35
    v_cvt_pk_bf16_f32 v49, v32, v32
    v_cvt_pk_bf16_f32 v50, v33, v33
    v_cvt_pk_bf16_f32 v51, v34, v34
    v_cvt_pk_bf16_f32 v52, v35, v35
    v_and_b32 v54, v49, v47
    v_and_b32 v55, v49, v48
    v_and_b32 v56, v50, v47
    v_and_b32 v57, v50, v48
    v_and_b32 v58, v51, v47
    v_and_b32 v59, v51, v48
    v_and_b32 v60, v52, v47
    v_and_b32 v61, v52, v48
    v_add_f32 v32, v32, v33
    v_add_f32 v34, v34, v35
    s_waitcnt vmcnt(12)
    v_mfma_f32_16x16x16_bf16 v[36:39], v[240:241], v[54:55], v[36:39]
    v_mfma_f32_16x16x16_bf16 v[40:43], v[242:243], v[54:55], v[40:43]
    v_add_f32 v46, v46, v32
    v_mfma_f32_16x16x16_bf16 v[36:39], v[244:245], v[56:57], v[36:39]
    v_mfma_f32_16x16x16_bf16 v[40:43], v[246:247], v[56:57], v[40:43]
    v_add_f32 v46, v46, v34
    v_mfma_f32_16x16x16_bf16 v[36:39], v[248:249], v[58:59], v[36:39]
    v_mfma_f32_16x16x16_bf16 v[40:43], v[250:251], v[58:59], v[40:43]
    v_mfma_f32_16x16x16_bf16 v[36:39], v[252:253], v[60:61], v[36:39]
    v_mfma_f32_16x16x16_bf16 v[40:43], v[254:255], v[60:61], v[40:43]
    buffer_load_dwordx4 v[240:243], v3, s[32:35], s49 offen offset:0 nt
    buffer_load_dwordx4 v[244:247], v3, s[32:35], s49 offen offset:256 nt
    buffer_load_dwordx4 v[248:251], v3, s[32:35], s49 offen offset:512 nt
    buffer_load_dwordx4 v[252:255], v3, s[32:35], s49 offen offset:768 nt
    s_cmp_lt_u32 s42, 2048
    s_cbranch_scc1 L_loop
L_sdone:
    v_mov_b32 v50, v46
    s_nop 1
    v_permlane32_swap_b32 v50, v46
    v_add_f32 v46, v46, v50
    v_mov_b32 v50, v46
    s_nop 1
    v_permlane16_swap_b32 v50, v46
    v_add_f32 v46, v46, v50
    ds_write2_b32 v9, v45, v46 offset0:0 offset1:4
    ds_write2_b32 v8, v36, v40 offset0:0 offset1:4
    ds_write2_b32 v8, v37, v41 offset0:8 offset1:12
    ds_write2_b32 v8, v38, v42 offset0:16 offset1:20
    ds_write2_b32 v8, v39, v43 offset0:24 offset1:28
    v_mov_b32 v33, v7
    v_mov_b32 v35, v7
    v_and_b32 v37, 1, v0
    v_cmp_eq_u32 vcc, 1, v37
    s_waitcnt lgkmcnt(0)
    s_barrier
    ds_read_b128 v[16:19], v10
    ds_read_b128 v[20:23], v10 offset:16
    ds_read_b64 v[24:25], v11 offset:0
    ds_read_b64 v[26:27], v11 offset:2112
    ds_read_b64 v[28:29], v11 offset:4224
    ds_read_b64 v[30:31], v11 offset:6336
    v_mov_b32 v37, v7
    v_mov_b32 v39, v7
    s_waitcnt lgkmcnt(5)
    v_max3_f32 v36, v16, v17, v18
    v_max_f32 v36, v36, v19
    v_sub_f32 v16, v16, v36
    v_sub_f32 v17, v17, v36
    v_sub_f32 v18, v18, v36
    v_sub_f32 v19, v19, v36
    v_exp_f32 v16, v16
    v_exp_f32 v17, v17
    v_exp_f32 v18, v18
    v_exp_f32 v19, v19
    s_waitcnt lgkmcnt(0)
    v_mul_f32 v38, v16, v20
    v_mul_f32 v32, v16, v24
    v_mul_f32 v33, v16, v25
    v_fmac_f32 v38, v17, v21
    v_fmac_f32 v32, v17, v26
    v_fmac_f32 v33, v17, v27
    v_fmac_f32 v38, v18, v22
    v_fmac_f32 v32, v18, v28
    v_fmac_f32 v33, v18, v29
    v_fmac_f32 v38, v19, v23
    v_fmac_f32 v32, v19, v30
    v_fmac_f32 v33, v19, v31
    v_cndmask_b32 v34, v36, v38, vcc
    buffer_store_dwordx4 v[32:35], v12, s[36:39], s45 offen sc1
    s_sub_u32 s43, 31, s27
    s_lshl3_add_u32 s43, s43, s26
    s_cmp_ge_u32 s43, 32
    s_cbranch_scc1 L_sfin
    v_lshlrev_b32 v6, 4, v0
    s_mul_i32 s47, s43, 32768
    s_mul_i32 s45, s3, 8192
    s_add_u32 s47, s47, s45
    s_add_u32 s47, s47, 2097152
    s_lshl_b32 s45, s3, 9
    v_lshlrev_b32 v8, 3, v0
    v_add_u32 v8, s45, v8
    s_mov_b32 s46, 200000
    s_add_u32 s48, s47, 4096
    s_barrier
    s_sleep 12
    buffer_load_dwordx4 v[64:67], v6, s[36:39], s47 offen offset:0 sc1
    buffer_load_dwordx4 v[68:71], v6, s[36:39], s47 offen offset:1024 sc1
    buffer_load_dwordx4 v[72:75], v6, s[36:39], s47 offen offset:2048 sc1
    buffer_load_dwordx4 v[76:79], v6, s[36:39], s47 offen offset:3072 sc1
    buffer_load_dwordx4 v[80:83], v6, s[36:39], s48 offen offset:0 sc1
    buffer_load_dwordx4 v[84:87], v6, s[36:39], s48 offen offset:1024 sc1
    buffer_load_dwordx4 v[88:91], v6, s[36:39], s48 offen offset:2048 sc1
    buffer_load_dwordx4 v[92:95], v6, s[36:39], s48 offen offset:3072 sc1
    s_sleep 8
L_g2:
    buffer_load_dwordx4 v[96:99], v6, s[36:39], s47 offen offset:0 sc1
    buffer_load_dwordx4 v[100:103], v6, s[36:39], s47 offen offset:1024 sc1
    buffer_load_dwordx4 v[104:107], v6, s[36:39], s47 offen offset:2048 sc1
    buffer_load_dwordx4 v[108:111], v6, s[36:39], s47 offen offset:3072 sc1
    buffer_load_dwordx4 v[112:115], v6, s[36:39], s48 offen offset:0 sc1
    buffer_load_dwordx4 v[116:119], v6, s[36:39], s48 offen offset:1024 sc1
    buffer_load_dwordx4 v[120:123], v6, s[36:39], s48 offen offset:2048 sc1
    buffer_load_dwordx4 v[124:127], v6, s[36:39], s48 offen offset:3072 sc1
    s_waitcnt vmcnt(8)
    v_min3_u32 v56, v7, v67, v71
    v_max3_u32 v57, v7, v67, v71
    v_min3_u32 v56, v56, v75, v79
    v_max3_u32 v57, v57, v75, v79
    v_min3_u32 v56, v56, v83, v87
    v_max3_u32 v57, v57, v83, v87
    v_min3_u32 v56, v56, v91, v95
    v_max3_u32 v57, v57, v91, v95
    v_cmp_ne_u32 vcc, v56, v57
    v_add_f32 v58, v64, v68
    v_add_f32 v59, v66, v70
    v_add_f32 v60, v72, v76
    v_add_f32 v61, v74, v78
    v_add_f32 v58, v58, v80
    v_add_f32 v59, v59, v82
    v_add_f32 v60, v60, v84
    v_add_f32 v61, v61, v86
    v_add_f32 v58, v58, v88
    v_add_f32 v59, v59, v90
    v_add_f32 v60, v60, v92
    v_add_f32 v61, v61, v94
    s_cbranch_vccz L_g2d
    buffer_load_dwordx4 v[64:67], v6, s[36:39], s47 offen offset:0 sc1
    buffer_load_dwordx4 v[68:71], v6, s[36:39], s47 offen offset:1024 sc1
    buffer_load_dwordx4 v[72:75], v6, s[36:39], s47 offen offset:2048 sc1
    buffer_load_dwordx4 v[76:79], v6, s[36:39], s47 offen offset:3072 sc1
    buffer_load_dwordx4 v[80:83], v6, s[36:39], s48 offen offset:0 sc1
    buffer_load_dwordx4 v[84:87], v6, s[36:39], s48 offen offset:1024 sc1
    buffer_load_dwordx4 v[88:91], v6, s[36:39], s48 offen offset:2048 sc1
    buffer_load_dwordx4 v[92:95], v6, s[36:39], s48 offen offset:3072 sc1
    s_waitcnt vmcnt(8)
    v_min3_u32 v56, v7, v99, v103
    v_max3_u32 v57, v7, v99, v103
    v_min3_u32 v56, v56, v107, v111
    v_max3_u32 v57, v57, v107, v111
    v_min3_u32 v56, v56, v115, v119
    v_max3_u32 v57, v57, v115, v119
    v_min3_u32 v56, v56, v123, v127
    v_max3_u32 v57, v57, v123, v127
    v_cmp_ne_u32 vcc, v56, v57
    v_add_f32 v58, v96, v100
    v_add_f32 v59, v98, v102
    v_add_f32 v60, v104, v108
    v_add_f32 v61, v106, v110
    v_add_f32 v58, v58, v112
    v_add_f32 v59, v59, v114
    v_add_f32 v60, v60, v116
    v_add_f32 v61, v61, v118
    v_add_f32 v58, v58, v120
    v_add_f32 v59, v59, v122
    v_add_f32 v60, v60, v124
    v_add_f32 v61, v61, v126
    s_cbranch_vccz L_g2d
    s_sub_u32 s46, s46, 1
    s_cbranch_scc0 L_g2
L_g2d:
    v_add_f32 v58, v58, v60
    v_add_f32 v59, v59, v61
    ds_write_b64 v8, v[58:59] offset:2048
    s_waitcnt lgkmcnt(0)
    s_barrier
L_sfin:
    s_waitcnt vmcnt(0)
    s_endpgm
    .p2align 12
L_tail:
    s_barrier
    s_cmp_lt_u32 s27, 14
    s_cbranch_scc1 L_gc
L_gcr:
L_pd:
    s_memrealtime s[84:85]
    s_waitcnt lgkmcnt(0)
    s_sub_u32 s84, s92, s84
    s_and_b32 s84, s84, 0xffffff
    s_cmp_lt_u32 s84, 256
    s_cbranch_scc1 L_pd
    buffer_load_dwordx4 v[208:211], v52, s[36:39], s40 offen offset:0 sc1
    buffer_load_dwordx4 v[212:215], v53, s[36:39], s40 offen offset:1024 sc1
    buffer_load_dwordx4 v[216:219], v54, s[36:39], s40 offen offset:2048 sc1
    buffer_load_dwordx4 v[220:223], v55, s[36:39], s40 offen offset:3072 sc1
    s_sleep 8
    buffer_load_dwordx4 v[224:227], v52, s[36:39], s40 offen offset:0 sc1
    buffer_load_dwordx4 v[228:231], v53, s[36:39], s40 offen offset:1024 sc1
    buffer_load_dwordx4 v[232:235], v54, s[36:39], s40 offen offset:2048 sc1
    buffer_load_dwordx4 v[236:239], v55, s[36:39], s40 offen offset:3072 sc1
    s_waitcnt vmcnt(22)
    v_perm_b32 v128, v140, v136, s44
    v_perm_b32 v129, v140, v136, s45
    v_perm_b32 v130, v141, v137, s44
    v_perm_b32 v131, v141, v137, s45
    v_perm_b32 v132, v142, v138, s44
    v_perm_b32 v133, v142, v138, s45
    v_perm_b32 v134, v143, v139, s44
    v_perm_b32 v135, v143, v139, s45
    s_waitcnt vmcnt(20)
    v_perm_b32 v136, v148, v144, s44
    v_perm_b32 v137, v148, v144, s45
    v_perm_b32 v138, v149, v145, s44
    v_perm_b32 v139, v149, v145, s45
    v_perm_b32 v140, v150, v146, s44
    v_perm_b32 v141, v150, v146, s45
    v_perm_b32 v142, v151, v147, s44
    v_perm_b32 v143, v151, v147, s45
    s_waitcnt vmcnt(18)
    v_perm_b32 v144, v156, v152, s44
    v_perm_b32 v145, v156, v152, s45
    v_perm_b32 v146, v157, v153, s44
    v_perm_b32 v147, v157, v153, s45
    v_perm_b32 v148, v158, v154, s44
    v_perm_b32 v149, v158, v154, s45
    v_perm_b32 v150, v159, v155, s44
    v_perm_b32 v151, v159, v155, s45
    s_waitcnt vmcnt(16)
    v_perm_b32 v152, v164, v160, s44
    v_perm_b32 v153, v164, v160, s45
    v_perm_b32 v154, v165, v161, s44
    v_perm_b32 v155, v165, v161, s45
    v_perm_b32 v156, v166, v162, s44
    v_perm_b32 v157, v166, v162, s45
    v_perm_b32 v158, v167, v163, s44
    v_perm_b32 v159, v167, v163, s45
    s_waitcnt vmcnt(14)
    v_perm_b32 v160, v172, v168, s44
    v_perm_b32 v161, v172, v168, s45
    v_perm_b32 v162, v173, v169, s44
    v_perm_b32 v163, v173, v169, s45
    v_perm_b32 v164, v174, v170, s44
    v_perm_b32 v165, v174, v170, s45
    v_perm_b32 v166, v175, v171, s44
    v_perm_b32 v167, v175, v171, s45
    s_waitcnt vmcnt(12)
    v_perm_b32 v168, v180, v176, s44
    v_perm_b32 v169, v180, v176, s45
    v_perm_b32 v170, v181, v177, s44
    v_perm_b32 v171, v181, v177, s45
    v_perm_b32 v172, v182, v178, s44
    v_perm_b32 v173, v182, v178, s45
    v_perm_b32 v174, v183, v179, s44
    v_perm_b32 v175, v183, v179, s45
    s_waitcnt vmcnt(10)
    v_perm_b32 v176, v188, v184, s44
    v_perm_b32 v177, v188, v184, s45
    v_perm_b32 v178, v189, v185, s44
    v_perm_b32 v179, v189, v185, s45
    v_perm_b32 v180, v190, v186, s44
    v_perm_b32 v181, v190, v186, s45
    v_perm_b32 v182, v191, v187, s44
    v_perm_b32 v183, v191, v187, s45
    s_waitcnt vmcnt(8)
    v_perm_b32 v184, v196, v192, s44
    v_perm_b32 v185, v196, v192, s45
    v_perm_b32 v186, v197, v193, s44
    v_perm_b32 v187, v197, v193, s45
    v_perm_b32 v188, v198, v194, s44
    v_perm_b32 v189, v198, v194, s45
    v_perm_b32 v190, v199, v195, s44
    v_perm_b32 v191, v199, v195, s45
    s_mov_b32 s46, 200000
L_h1:
    s_waitcnt vmcnt(4)
    v_cmp_eq_u32 s[84:85], v7, v211
    v_cmp_eq_u32 s[86:87], v7, v215
    v_cmp_eq_u32 s[88:89], v7, v219
    v_cmp_eq_u32 s[90:91], v7, v223
    v_cndmask_b32 v52, v52, v56, s[84:85]
    v_cndmask_b32 v53, v53, v56, s[86:87]
    v_cndmask_b32 v54, v54, v56, s[88:89]
    v_cndmask_b32 v55, v55, v56, s[90:91]
    v_min3_u32 v57, v52, v53, v54
    v_min_u32 v57, v57, v55
    v_cmp_gt_u32 vcc, v56, v57
    v_cndmask_b32 v48, v48, v210, s[84:85]
    v_cndmask_b32 v49, v49, v214, s[86:87]
    v_cndmask_b32 v50, v50, v218, s[88:89]
    v_cndmask_b32 v51, v51, v222, s[90:91]
    v_cndmask_b32 v40, v40, v208, s[84:85]
    v_cndmask_b32 v41, v41, v212, s[86:87]
    v_cndmask_b32 v42, v42, v216, s[88:89]
    v_cndmask_b32 v43, v43, v220, s[90:91]
    v_cndmask_b32 v44, v44, v209, s[84:85]
    v_cndmask_b32 v45, v45, v213, s[86:87]
    v_cndmask_b32 v46, v46, v217, s[88:89]
    v_cndmask_b32 v47, v47, v221, s[90:91]
    s_cbranch_vccz L_h1d
    buffer_load_dwordx4 v[208:211], v52, s[36:39], s40 offen offset:0 sc1
    buffer_load_dwordx4 v[212:215], v53, s[36:39], s40 offen offset:1024 sc1
    buffer_load_dwordx4 v[216:219], v54, s[36:39], s40 offen offset:2048 sc1
    buffer_load_dwordx4 v[220:223], v55, s[36:39], s40 offen offset:3072 sc1
    s_waitcnt vmcnt(4)
    v_cmp_eq_u32 s[84:85], v7, v227
    v_cmp_eq_u32 s[86:87], v7, v231
    v_cmp_eq_u32 s[88:89], v7, v235
    v_cmp_eq_u32 s[90:91], v7, v239
    v_cndmask_b32 v52, v52, v56, s[84:85]
    v_cndmask_b32 v53, v53, v56, s[86:87]
    v_cndmask_b32 v54, v54, v56, s[88:89]
    v_cndmask_b32 v55, v55, v56, s[90:91]
    v_min3_u32 v57, v52, v53, v54
    v_min_u32 v57, v57, v55
    v_cmp_gt_u32 vcc, v56, v57
    v_cndmask_b32 v48, v48, v226, s[84:85]
    v_cndmask_b32 v49, v49, v230, s[86:87]
    v_cndmask_b32 v50, v50, v234, s[88:89]
    v_cndmask_b32 v51, v51, v238, s[90:91]
    v_cndmask_b32 v40, v40, v224, s[84:85]
    v_cndmask_b32 v41, v41, v228, s[86:87]
    v_cndmask_b32 v42, v42, v232, s[88:89]
    v_cndmask_b32 v43, v43, v236, s[90:91]
    v_cndmask_b32 v44, v44, v225, s[84:85]
    v_cndmask_b32 v45, v45, v229, s[86:87]
    v_cndmask_b32 v46, v46, v233, s[88:89]
    v_cndmask_b32 v47, v47, v237, s[90:91]
    s_cbranch_vccz L_h1d
    buffer_load_dwordx4 v[224:227], v52, s[36:39], s40 offen offset:0 sc1
    buffer_load_dwordx4 v[228:231], v53, s[36:39], s40 offen offset:1024 sc1
    buffer_load_dwordx4 v[232:235], v54, s[36:39], s40 offen offset:2048 sc1
    buffer_load_dwordx4 v[236:239], v55, s[36:39], s40 offen offset:3072 sc1
    s_sub_u32 s46, s46, 1
    s_cbranch_scc0 L_h1
L_h1d:
    v_max3_f32 v52, v48, v49, v50
    v_max_f32 v52, v52, v51
    s_nop 1
    v_max_f32_dpp v52, v52, v52 row_ror:8 row_mask:0xf bank_mask:0xf
    v_mov_b32 v53, v52
    s_nop 1
    v_permlane32_swap_b32 v53, v52
    v_max_f32 v52, v52, v53
    v_mov_b32 v53, v52
    s_nop 1
    v_permlane16_swap_b32 v53, v52
    v_max_f32 v52, v52, v53
    v_sub_f32 v1, v48, v52
    v_sub_f32 v2, v49, v52
    v_sub_f32 v3, v50, v52
    v_sub_f32 v4, v51, v52
    v_exp_f32 v1, v1
    v_exp_f32 v2, v2
    v_exp_f32 v3, v3
    v_exp_f32 v4, v4
    v_mov_b32_dpp v52, v1 quad_perm:[0,0,2,2] row_mask:0xf bank_mask:0xf
    v_mov_b32_dpp v53, v2 quad_perm:[0,0,2,2] row_mask:0xf bank_mask:0xf
    v_mov_b32_dpp v54, v3 quad_perm:[0,0,2,2] row_mask:0xf bank_mask:0xf
    v_mov_b32_dpp v55, v4 quad_perm:[0,0,2,2] row_mask:0xf bank_mask:0xf
    v_mul_f32 v40, v52, v40
    v_mul_f32 v44, v52, v44
    v_mul_f32 v48, v52, v48
    v_fmac_f32 v40, v53, v41
    v_fmac_f32 v44, v53, v45
    v_fmac_f32 v48, v53, v49
    v_fmac_f32 v40, v54, v42
    v_fmac_f32 v44, v54, v46
    v_fmac_f32 v48, v54, v50
    v_fmac_f32 v40, v55, v43
    v_fmac_f32 v44, v55, v47
    v_fmac_f32 v48, v55, v51
    s_nop 1
    v_add_f32_dpp v48, v48, v48 row_ror:8 row_mask:0xf bank_mask:0xf
    v_add_f32_dpp v40, v40, v40 row_ror:8 row_mask:0xf bank_mask:0xf
    v_add_f32_dpp v44, v44, v44 row_ror:8 row_mask:0xf bank_mask:0xf
    v_mov_b32 v43, v48
    v_mov_b32 v45, v40
    v_mov_b32 v46, v44
    v_permlane32_swap_b32 v43, v48
    v_permlane32_swap_b32 v45, v40
    v_permlane32_swap_b32 v46, v44
    v_add_f32 v48, v48, v43
    v_add_f32 v40, v40, v45
    v_add_f32 v44, v44, v46
    v_mov_b32 v43, v48
    v_mov_b32 v45, v40
    v_mov_b32 v46, v44
    v_permlane16_swap_b32 v43, v48
    v_permlane16_swap_b32 v45, v40
    v_permlane16_swap_b32 v46, v44
    v_add_f32 v48, v48, v43
    v_add_f32 v40, v40, v45
    v_add_f32 v44, v44, v46
    v_mov_b32_dpp v42, v48 quad_perm:[1,1,3,3] row_mask:0xf bank_mask:0xf
    v_mov_b32 v41, v44
    v_rcp_f32 v42, v42
    s_nop 0
    v_mul_f32 v40, v40, v42
    v_mul_f32 v41, v41, v42
    v_cvt_pk_bf16_f32 v40, v40, v41
    s_nop 0
    v_readlane_b32 s48, v40, 0
    v_readlane_b32 s49, v40, 1
    v_readlane_b32 s50, v40, 2
    v_readlane_b32 s51, v40, 3
    v_readlane_b32 s52, v40, 4
    v_readlane_b32 s53, v40, 5
    v_readlane_b32 s54, v40, 6
    v_readlane_b32 s55, v40, 7
    v_dot2c_f32_bf16 v16, s48, v128
    v_dot2c_f32_bf16 v18, s48, v129
    v_dot2c_f32_bf16 v20, s48, v130
    v_dot2c_f32_bf16 v22, s48, v131
    v_dot2c_f32_bf16 v24, s48, v132
    v_dot2c_f32_bf16 v26, s48, v133
    v_dot2c_f32_bf16 v28, s48, v134
    v_dot2c_f32_bf16 v30, s48, v135
    v_dot2c_f32_bf16 v16, s49, v136
    v_dot2c_f32_bf16 v18, s49, v137
    v_dot2c_f32_bf16 v20, s49, v138
    v_dot2c_f32_bf16 v22, s49, v139
    v_dot2c_f32_bf16 v24, s49, v140
    v_dot2c_f32_bf16 v26, s49, v141
    v_dot2c_f32_bf16 v28, s49, v142
    v_dot2c_f32_bf16 v30, s49, v143
    v_dot2c_f32_bf16 v16, s50, v144
    v_dot2c_f32_bf16 v18, s50, v145
    v_dot2c_f32_bf16 v20, s50, v146
    v_dot2c_f32_bf16 v22, s50, v147
    v_dot2c_f32_bf16 v24, s50, v148
    v_dot2c_f32_bf16 v26, s50, v149
    v_dot2c_f32_bf16 v28, s50, v150
    v_dot2c_f32_bf16 v30, s50, v151
    v_dot2c_f32_bf16 v16, s51, v152
    v_dot2c_f32_bf16 v18, s51, v153
    v_dot2c_f32_bf16 v20, s51, v154
    v_dot2c_f32_bf16 v22, s51, v155
    v_dot2c_f32_bf16 v24, s51, v156
    v_dot2c_f32_bf16 v26, s51, v157
    v_dot2c_f32_bf16 v28, s51, v158
    v_dot2c_f32_bf16 v30, s51, v159
    v_dot2c_f32_bf16 v16, s52, v160
    v_dot2c_f32_bf16 v18, s52, v161
    v_dot2c_f32_bf16 v20, s52, v162
    v_dot2c_f32_bf16 v22, s52, v163
    v_dot2c_f32_bf16 v24, s52, v164
    v_dot2c_f32_bf16 v26, s52, v165
    v_dot2c_f32_bf16 v28, s52, v166
    v_dot2c_f32_bf16 v30, s52, v167
    v_dot2c_f32_bf16 v16, s53, v168
    v_dot2c_f32_bf16 v18, s53, v169
    v_dot2c_f32_bf16 v20, s53, v170
    v_dot2c_f32_bf16 v22, s53, v171
    v_dot2c_f32_bf16 v24, s53, v172
    v_dot2c_f32_bf16 v26, s53, v173
    v_dot2c_f32_bf16 v28, s53, v174
    v_dot2c_f32_bf16 v30, s53, v175
    v_dot2c_f32_bf16 v16, s54, v176
    v_dot2c_f32_bf16 v18, s54, v177
    v_dot2c_f32_bf16 v20, s54, v178
    v_dot2c_f32_bf16 v22, s54, v179
    v_dot2c_f32_bf16 v24, s54, v180
    v_dot2c_f32_bf16 v26, s54, v181
    v_dot2c_f32_bf16 v28, s54, v182
    v_dot2c_f32_bf16 v30, s54, v183
    v_dot2c_f32_bf16 v16, s55, v184
    v_dot2c_f32_bf16 v18, s55, v185
    v_dot2c_f32_bf16 v20, s55, v186
    v_dot2c_f32_bf16 v22, s55, v187
    v_dot2c_f32_bf16 v24, s55, v188
    v_dot2c_f32_bf16 v26, s55, v189
    v_dot2c_f32_bf16 v28, s55, v190
    v_dot2c_f32_bf16 v30, s55, v191
    buffer_store_dwordx4 v[16:19], v5, s[36:39], s56 offen sc1
    buffer_store_dwordx4 v[20:23], v5, s[36:39], s57 offen sc1
    buffer_store_dwordx4 v[24:27], v5, s[36:39], s58 offen sc1
    buffer_store_dwordx4 v[28:31], v5, s[36:39], s59 offen sc1
    s_cmp_ge_u32 s43, 32
    s_cbranch_scc1 L_fin
    s_mul_i32 s47, s43, 16384
    s_add_u32 s47, s47, 65536
    s_mov_b32 s46, 200000
    buffer_load_dwordx4 v[64:67], v6, s[36:39], s47 offen offset:0 sc1
    buffer_load_dwordx4 v[68:71], v6, s[36:39], s47 offen offset:1024 sc1
    buffer_load_dwordx4 v[72:75], v6, s[36:39], s47 offen offset:2048 sc1
    buffer_load_dwordx4 v[76:79], v6, s[36:39], s47 offen offset:3072 sc1
    s_add_u32 s47, s47, 4096
    buffer_load_dwordx4 v[80:83], v6, s[36:39], s47 offen offset:0 sc1
    buffer_load_dwordx4 v[84:87], v6, s[36:39], s47 offen offset:1024 sc1
    buffer_load_dwordx4 v[88:91], v6, s[36:39], s47 offen offset:2048 sc1
    buffer_load_dwordx4 v[92:95], v6, s[36:39], s47 offen offset:3072 sc1
    s_add_u32 s47, s47, 4096
    buffer_load_dwordx4 v[96:99], v6, s[36:39], s47 offen offset:0 sc1
    buffer_load_dwordx4 v[100:103], v6, s[36:39], s47 offen offset:1024 sc1
    buffer_load_dwordx4 v[104:107], v6, s[36:39], s47 offen offset:2048 sc1
    buffer_load_dwordx4 v[108:111], v6, s[36:39], s47 offen offset:3072 sc1
    s_add_u32 s47, s47, 4096
    buffer_load_dwordx4 v[112:115], v6, s[36:39], s47 offen offset:0 sc1
    buffer_load_dwordx4 v[116:119], v6, s[36:39], s47 offen offset:1024 sc1
    s_sub_u32 s47, s47, 12288
    s_barrier
    s_branch L_pollw2
L_poll2:
    buffer_load_dwordx4 v[64:67], v6, s[36:39], s47 offen offset:0 sc1
    buffer_load_dwordx4 v[68:71], v6, s[36:39], s47 offen offset:1024 sc1
    buffer_load_dwordx4 v[72:75], v6, s[36:39], s47 offen offset:2048 sc1
    buffer_load_dwordx4 v[76:79], v6, s[36:39], s47 offen offset:3072 sc1
    s_add_u32 s47, s47, 4096
    buffer_load_dwordx4 v[80:83], v6, s[36:39], s47 offen offset:0 sc1
    buffer_load_dwordx4 v[84:87], v6, s[36:39], s47 offen offset:1024 sc1
    buffer_load_dwordx4 v[88:91], v6, s[36:39], s47 offen offset:2048 sc1
    buffer_load_dwordx4 v[92:95], v6, s[36:39], s47 offen offset:3072 sc1
    s_add_u32 s47, s47, 4096
    buffer_load_dwordx4 v[96:99], v6, s[36:39], s47 offen offset:0 sc1
    buffer_load_dwordx4 v[100:103], v6, s[36:39], s47 offen offset:1024 sc1
    buffer_load_dwordx4 v[104:107], v6, s[36:39], s47 offen offset:2048 sc1
    buffer_load_dwordx4 v[108:111], v6, s[36:39], s47 offen offset:3072 sc1
    s_add_u32 s47, s47, 4096
    buffer_load_dwordx4 v[112:115], v6, s[36:39], s47 offen offset:0 sc1
    buffer_load_dwordx4 v[116:119], v6, s[36:39], s47 offen offset:1024 sc1
    s_sub_u32 s47, s47, 12288
L_pollw2:
    s_waitcnt vmcnt(0)
    v_mov_b32 v56, v7
    v_mov_b32 v57, v7
    v_min3_u32 v56, v56, v65, v67
    v_max3_u32 v57, v57, v65, v67
    v_min3_u32 v56, v56, v69, v71
    v_max3_u32 v57, v57, v69, v71
    v_min3_u32 v56, v56, v73, v75
    v_max3_u32 v57, v57, v73, v75
    v_min3_u32 v56, v56, v77, v79
    v_max3_u32 v57, v57, v77, v79
    v_min3_u32 v56, v56, v81, v83
    v_max3_u32 v57, v57, v81, v83
    v_min3_u32 v56, v56, v85, v87
    v_max3_u32 v57, v57, v85, v87
    v_min3_u32 v56, v56, v89, v91
    v_max3_u32 v57, v57, v89, v91
    v_min3_u32 v56, v56, v93, v95
    v_max3_u32 v57, v57, v93, v95
    v_min3_u32 v56, v56, v97, v99
    v_max3_u32 v57, v57, v97, v99
    v_min3_u32 v56, v56, v101, v103
    v_max3_u32 v57, v57, v101, v103
    v_min3_u32 v56, v56, v105, v107
    v_max3_u32 v57, v57, v105, v107
    v_min3_u32 v56, v56, v109, v111
    v_max3_u32 v57, v57, v109, v111
    v_min3_u32 v56, v56, v113, v115
    v_max3_u32 v57, v57, v113, v115
    v_min3_u32 v56, v56, v117, v119
    v_max3_u32 v57, v57, v117, v119
    v_cmp_ne_u32 vcc, v56, v57
    s_cbranch_vccz L_pdone2
    s_sub_u32 s46, s46, 1
    s_cbranch_scc1 L_pdone2
    s_sleep 1
    s_branch L_poll2
L_pdone2:
    v_add_f32 v60, v64, v68
    v_add_f32 v61, v66, v70
    v_add_f32 v60, v60, v72
    v_add_f32 v61, v61, v74
    v_add_f32 v60, v60, v76
    v_add_f32 v61, v61, v78
    v_add_f32 v60, v60, v80
    v_add_f32 v61, v61, v82
    v_add_f32 v60, v60, v84
    v_add_f32 v61, v61, v86
    v_add_f32 v60, v60, v88
    v_add_f32 v61, v61, v90
    v_add_f32 v60, v60, v92
    v_add_f32 v61, v61, v94
    v_add_f32 v60, v60, v96
    v_add_f32 v61, v61, v98
    v_add_f32 v60, v60, v100
    v_add_f32 v61, v61, v102
    v_add_f32 v60, v60, v104
    v_add_f32 v61, v61, v106
    v_add_f32 v60, v60, v108
    v_add_f32 v61, v61, v110
    v_add_f32 v60, v60, v112
    v_add_f32 v61, v61, v114
    v_add_f32 v60, v60, v116
    v_add_f32 v61, v61, v118
    s_nop 0
    v_add_f32_dpp v60, v60, v60 row_ror:8 row_mask:0xf bank_mask:0xf
    v_add_f32_dpp v61, v61, v61 row_ror:8 row_mask:0xf bank_mask:0xf
    v_mov_b32 v56, v60
    v_mov_b32 v57, v61
    s_nop 0
    v_permlane32_swap_b32 v56, v60
    v_permlane32_swap_b32 v57, v61
    v_add_f32 v60, v60, v56
    v_add_f32 v61, v61, v57
    v_mov_b32 v56, v60
    v_mov_b32 v57, v61
    s_nop 0
    v_permlane16_swap_b32 v56, v60
    v_permlane16_swap_b32 v57, v61
    v_add_f32 v60, v60, v56
    v_add_f32 v61, v61, v57
    v_cvt_pk_bf16_f32 v60, v60, v60
    v_and_b32 v60, 0xffff0000, v60
    v_mul_f32 v56, 0xbfb8aa3b, v60
    v_exp_f32 v56, v56
    s_nop 0
    v_add_f32 v56, 1.0, v56
    v_rcp_f32 v56, v56
    s_nop 0
    v_mul_f32 v60, v60, v56
    v_cvt_pk_bf16_f32 v60, v60, v60
    v_and_b32 v60, 0xffff0000, v60
    v_cvt_pk_bf16_f32 v61, v61, v61
    v_and_b32 v61, 0xffff0000, v61
    v_mul_f32 v56, 0xbfb8aa3b, v61
    v_exp_f32 v56, v56
    s_nop 0
    v_add_f32 v56, 1.0, v56
    v_rcp_f32 v56, v56
    s_nop 0
    v_mul_f32 v61, v61, v56
    v_cvt_pk_bf16_f32 v61, v61, v61
    v_and_b32 v61, 0xffff0000, v61
L_nog:
    v_lshlrev_b32 v6, 3, v0
    v_lshlrev_b32 v16, 16, v63
    v_and_b32 v17, 0xffff0000, v63
    s_barrier
    ds_read_b64 v[8:9], v6 offset:2048
    ds_read_b64 v[10:11], v6 offset:2560
    ds_read_b64 v[12:13], v6 offset:3072
    ds_read_b64 v[14:15], v6 offset:3584
    s_waitcnt lgkmcnt(2)
    v_add_f32 v58, v8, v10
    v_add_f32 v59, v9, v11
    s_waitcnt lgkmcnt(0)
    v_add_f32 v12, v12, v14
    v_add_f32 v13, v13, v15
    v_add_f32 v58, v58, v12
    v_add_f32 v59, v59, v13
    s_nop 0
    v_add_f32_dpp v58, v58, v58 row_ror:8 row_mask:0xf bank_mask:0xf
    v_add_f32_dpp v59, v59, v59 row_ror:8 row_mask:0xf bank_mask:0xf
    v_mov_b32 v56, v58
    v_mov_b32 v57, v59
    s_nop 0
    v_permlane32_swap_b32 v56, v58
    v_permlane32_swap_b32 v57, v59
    v_add_f32 v58, v58, v56
    v_add_f32 v59, v59, v57
    v_mov_b32 v56, v58
    v_mov_b32 v57, v59
    s_nop 0
    v_permlane16_swap_b32 v56, v58
    v_permlane16_swap_b32 v57, v59
    v_add_f32 v58, v58, v56
    v_add_f32 v59, v59, v57
    v_cvt_pk_bf16_f32 v58, v58, v58
    v_and_b32 v58, 0xffff0000, v58
    v_cvt_pk_bf16_f32 v59, v59, v59
    v_and_b32 v59, 0xffff0000, v59
    v_mul_f32 v58, v58, v60
    v_mul_f32 v59, v59, v61
    v_cvt_pk_bf16_f32 v58, v58, v58
    v_and_b32 v58, 0xffff0000, v58
    v_cvt_pk_bf16_f32 v59, v59, v59
    v_and_b32 v59, 0xffff0000, v59
    v_add_f32 v58, v58, v16
    v_add_f32 v59, v59, v17
    v_cvt_pk_bf16_f32 v58, v58, v59
    s_mov_b64 exec, 255
    buffer_store_dword v58, v62, s[32:35], 0 offen
    s_cmp_lg_u32 s43, 0
    s_cbranch_scc1 L_fin
    v_add_u32 v7, 0x61c88648, v7
    s_mov_b64 exec, 1
    buffer_store_dword v7, off, s[36:39], 0 offset:0 sc1
L_fin:
    s_waitcnt vmcnt(0)
L_end:
    s_endpgm
L_gc:
    s_waitcnt vmcnt(30)
    v_perm_b32 v200, v68, v64, s44
    v_perm_b32 v201, v68, v64, s45
    v_perm_b32 v202, v69, v65, s44
    v_perm_b32 v203, v69, v65, s45
    v_perm_b32 v204, v70, v66, s44
    v_perm_b32 v205, v70, v66, s45
    v_perm_b32 v206, v71, v67, s44
    v_perm_b32 v207, v71, v67, s45
    v_dot2c_f32_bf16 v240, s48, v200
    v_dot2c_f32_bf16 v242, s48, v201
    v_dot2c_f32_bf16 v244, s48, v202
    v_dot2c_f32_bf16 v246, s48, v203
    v_dot2c_f32_bf16 v248, s48, v204
    v_dot2c_f32_bf16 v250, s48, v205
    v_dot2c_f32_bf16 v252, s48, v206
    v_dot2c_f32_bf16 v254, s48, v207
    s_waitcnt vmcnt(28)
    v_perm_b32 v208, v76, v72, s44
    v_perm_b32 v209, v76, v72, s45
    v_perm_b32 v210, v77, v73, s44
    v_perm_b32 v211, v77, v73, s45
    v_perm_b32 v212, v78, v74, s44
    v_perm_b32 v213, v78, v74, s45
    v_perm_b32 v214, v79, v75, s44
    v_perm_b32 v215, v79, v75, s45
    v_dot2c_f32_bf16 v240, s49, v208
    v_dot2c_f32_bf16 v242, s49, v209
    v_dot2c_f32_bf16 v244, s49, v210
    v_dot2c_f32_bf16 v246, s49, v211
    v_dot2c_f32_bf16 v248, s49, v212
    v_dot2c_f32_bf16 v250, s49, v213
    v_dot2c_f32_bf16 v252, s49, v214
    v_dot2c_f32_bf16 v254, s49, v215
    s_waitcnt vmcnt(26)
    v_perm_b32 v200, v84, v80, s44
    v_perm_b32 v201, v84, v80, s45
    v_perm_b32 v202, v85, v81, s44
    v_perm_b32 v203, v85, v81, s45
    v_perm_b32 v204, v86, v82, s44
    v_perm_b32 v205, v86, v82, s45
    v_perm_b32 v206, v87, v83, s44
    v_perm_b32 v207, v87, v83, s45
    v_dot2c_f32_bf16 v240, s50, v200
    v_dot2c_f32_bf16 v242, s50, v201
    v_dot2c_f32_bf16 v244, s50, v202
    v_dot2c_f32_bf16 v246, s50, v203
    v_dot2c_f32_bf16 v248, s50, v204
    v_dot2c_f32_bf16 v250, s50, v205
    v_dot2c_f32_bf16 v252, s50, v206
    v_dot2c_f32_bf16 v254, s50, v207
    s_waitcnt vmcnt(24)
    v_perm_b32 v208, v92, v88, s44
    v_perm_b32 v209, v92, v88, s45
    v_perm_b32 v210, v93, v89, s44
    v_perm_b32 v211, v93, v89, s45
    v_perm_b32 v212, v94, v90, s44
    v_perm_b32 v213, v94, v90, s45
    v_perm_b32 v214, v95, v91, s44
    v_perm_b32 v215, v95, v91, s45
    v_dot2c_f32_bf16 v240, s51, v208
    v_dot2c_f32_bf16 v242, s51, v209
    v_dot2c_f32_bf16 v244, s51, v210
    v_dot2c_f32_bf16 v246, s51, v211
    v_dot2c_f32_bf16 v248, s51, v212
    v_dot2c_f32_bf16 v250, s51, v213
    v_dot2c_f32_bf16 v252, s51, v214
    v_dot2c_f32_bf16 v254, s51, v215
    s_waitcnt vmcnt(22)
    v_perm_b32 v200, v100, v96, s44
    v_perm_b32 v201, v100, v96, s45
    v_perm_b32 v202, v101, v97, s44
    v_perm_b32 v203, v101, v97, s45
    v_perm_b32 v204, v102, v98, s44
    v_perm_b32 v205, v102, v98, s45
    v_perm_b32 v206, v103, v99, s44
    v_perm_b32 v207, v103, v99, s45
    v_dot2c_f32_bf16 v240, s52, v200
    v_dot2c_f32_bf16 v242, s52, v201
    v_dot2c_f32_bf16 v244, s52, v202
    v_dot2c_f32_bf16 v246, s52, v203
    v_dot2c_f32_bf16 v248, s52, v204
    v_dot2c_f32_bf16 v250, s52, v205
    v_dot2c_f32_bf16 v252, s52, v206
    v_dot2c_f32_bf16 v254, s52, v207
    s_waitcnt vmcnt(20)
    v_perm_b32 v208, v108, v104, s44
    v_perm_b32 v209, v108, v104, s45
    v_perm_b32 v210, v109, v105, s44
    v_perm_b32 v211, v109, v105, s45
    v_perm_b32 v212, v110, v106, s44
    v_perm_b32 v213, v110, v106, s45
    v_perm_b32 v214, v111, v107, s44
    v_perm_b32 v215, v111, v107, s45
    v_dot2c_f32_bf16 v240, s53, v208
    v_dot2c_f32_bf16 v242, s53, v209
    v_dot2c_f32_bf16 v244, s53, v210
    v_dot2c_f32_bf16 v246, s53, v211
    v_dot2c_f32_bf16 v248, s53, v212
    v_dot2c_f32_bf16 v250, s53, v213
    v_dot2c_f32_bf16 v252, s53, v214
    v_dot2c_f32_bf16 v254, s53, v215
    s_waitcnt vmcnt(18)
    v_perm_b32 v200, v116, v112, s44
    v_perm_b32 v201, v116, v112, s45
    v_perm_b32 v202, v117, v113, s44
    v_perm_b32 v203, v117, v113, s45
    v_perm_b32 v204, v118, v114, s44
    v_perm_b32 v205, v118, v114, s45
    v_perm_b32 v206, v119, v115, s44
    v_perm_b32 v207, v119, v115, s45
    v_dot2c_f32_bf16 v240, s54, v200
    v_dot2c_f32_bf16 v242, s54, v201
    v_dot2c_f32_bf16 v244, s54, v202
    v_dot2c_f32_bf16 v246, s54, v203
    v_dot2c_f32_bf16 v248, s54, v204
    v_dot2c_f32_bf16 v250, s54, v205
    v_dot2c_f32_bf16 v252, s54, v206
    v_dot2c_f32_bf16 v254, s54, v207
    s_waitcnt vmcnt(16)
    v_perm_b32 v208, v124, v120, s44
    v_perm_b32 v209, v124, v120, s45
    v_perm_b32 v210, v125, v121, s44
    v_perm_b32 v211, v125, v121, s45
    v_perm_b32 v212, v126, v122, s44
    v_perm_b32 v213, v126, v122, s45
    v_perm_b32 v214, v127, v123, s44
    v_perm_b32 v215, v127, v123, s45
    v_dot2c_f32_bf16 v240, s55, v208
    v_dot2c_f32_bf16 v242, s55, v209
    v_dot2c_f32_bf16 v244, s55, v210
    v_dot2c_f32_bf16 v246, s55, v211
    v_dot2c_f32_bf16 v248, s55, v212
    v_dot2c_f32_bf16 v250, s55, v213
    v_dot2c_f32_bf16 v252, s55, v214
    v_dot2c_f32_bf16 v254, s55, v215
    s_cmp_lg_u32 s94, 0
    s_cbranch_scc1 L_gcdry
    buffer_store_dwordx4 v[240:243], v39, s[36:39], s80 offen sc1
    buffer_store_dwordx4 v[244:247], v39, s[36:39], s81 offen sc1
    buffer_store_dwordx4 v[248:251], v39, s[36:39], s82 offen sc1
    buffer_store_dwordx4 v[252:255], v39, s[36:39], s83 offen sc1
    s_branch L_gcr
    .p2align 12
L_service:
    s_setprio 3
    s_mov_b32 s44, 0x05040100
    s_mov_b32 s45, 0x07060302
    s_sub_u32 s43, 31, s27
    s_lshl3_add_u32 s43, s43, s26
    v_lshrrev_b32 v6, 4, v0
    v_lshlrev_b32 v6, 2, v6
    v_add_u32 v6, v5, v6
    v_and_b32 v36, 3, v0
    v_lshlrev_b32 v37, 3, v36
    v_lshrrev_b32 v38, 2, v0
    v_lshlrev_b32 v38, 11, v38
    v_lshl_add_u32 v38, v36, 4, v38
    s_lshl_b32 s40, s26, 16
    s_add_u32 s40, s40, 3145728
    s_lshl_b32 s41, s22, 6
    s_add_u32 s41, s41, s40
    s_add_u32 s42, s41, 0x8000
    s_and_b32 s46, s27, 0
    s_lshl_b32 s46, s46, 11
    s_add_u32 s40, s40, s46
    v_mul_u32_u24 v3, 57344, v4
    v_add_u32 v3, v3, v5
    s_waitcnt vmcnt(16)
    v_lshlrev_b32 v16, 16, v8
    v_and_b32 v17, 0xffff0000, v8
    v_lshlrev_b32 v18, 16, v9
    v_and_b32 v19, 0xffff0000, v9
    v_lshlrev_b32 v20, 16, v10
    v_and_b32 v21, 0xffff0000, v10
    v_lshlrev_b32 v22, 16, v11
    v_and_b32 v23, 0xffff0000, v11
    v_lshlrev_b32 v24, 16, v12
    v_and_b32 v25, 0xffff0000, v12
    v_lshlrev_b32 v26, 16, v13
    v_and_b32 v27, 0xffff0000, v13
    v_lshlrev_b32 v28, 16, v14
    v_and_b32 v29, 0xffff0000, v14
    v_lshlrev_b32 v30, 16, v15
    v_and_b32 v31, 0xffff0000, v15
    v_add_f32 v32, v16, v17
    v_add_f32 v33, v18, v19
    v_add_f32 v32, v32, v20
    v_add_f32 v32, v32, v21
    v_add_f32 v33, v33, v22
    v_add_f32 v33, v33, v23
    v_add_f32 v32, v32, v24
    v_add_f32 v32, v32, v25
    v_add_f32 v33, v33, v26
    v_add_f32 v33, v33, v27
    v_add_f32 v32, v32, v28
    v_add_f32 v32, v32, v29
    v_add_f32 v33, v33, v30
    v_add_f32 v33, v33, v31
    v_add_f32 v32, v32, v33
    s_nop 1
    v_add_f32_dpp v32, v32, v32 quad_perm:[2,3,0,1] row_mask:0xf bank_mask:0xf
    s_nop 1
    v_add_f32_dpp v32, v32, v32 row_ror:4 row_mask:0xf bank_mask:0xf
    s_nop 1
    v_add_f32_dpp v32, v32, v32 row_ror:8 row_mask:0xf bank_mask:0xf
    v_mov_b32 v33, v32
    s_nop 1
    v_permlane32_swap_b32 v33, v32
    v_add_f32 v32, v32, v33
    v_mov_b32 v33, v32
    s_nop 1
    v_permlane16_swap_b32 v33, v32
    v_add_f32 v32, v32, v33
    v_mul_f32 v32, 0x3b000000, v32
    v_mov_b32 v34, 0
    v_mov_b32 v35, 0
    v_sub_f32 v33, v16, v32
    v_fmac_f32 v34, v33, v33
    v_sub_f32 v33, v17, v32
    v_fmac_f32 v35, v33, v33
    v_sub_f32 v33, v18, v32
    v_fmac_f32 v34, v33, v33
    v_sub_f32 v33, v19, v32
    v_fmac_f32 v35, v33, v33
    v_sub_f32 v33, v20, v32
    v_fmac_f32 v34, v33, v33
    v_sub_f32 v33, v21, v32
    v_fmac_f32 v35, v33, v33
    v_sub_f32 v33, v22, v32
    v_fmac_f32 v34, v33, v33
    v_sub_f32 v33, v23, v32
    v_fmac_f32 v35, v33, v33
    v_sub_f32 v33, v24, v32
    v_fmac_f32 v34, v33, v33
    v_sub_f32 v33, v25, v32
    v_fmac_f32 v35, v33, v33
    v_sub_f32 v33, v26, v32
    v_fmac_f32 v34, v33, v33
    v_sub_f32 v33, v27, v32
    v_fmac_f32 v35, v33, v33
    v_sub_f32 v33, v28, v32
    v_fmac_f32 v34, v33, v33
    v_sub_f32 v33, v29, v32
    v_fmac_f32 v35, v33, v33
    v_sub_f32 v33, v30, v32
    v_fmac_f32 v34, v33, v33
    v_sub_f32 v33, v31, v32
    v_fmac_f32 v35, v33, v33
    v_add_f32 v34, v34, v35
    s_nop 1
    v_add_f32_dpp v34, v34, v34 quad_perm:[2,3,0,1] row_mask:0xf bank_mask:0xf
    s_nop 1
    v_add_f32_dpp v34, v34, v34 row_ror:4 row_mask:0xf bank_mask:0xf
    s_nop 1
    v_add_f32_dpp v34, v34, v34 row_ror:8 row_mask:0xf bank_mask:0xf
    v_mov_b32 v33, v34
    s_nop 1
    v_permlane32_swap_b32 v33, v34
    v_add_f32 v34, v34, v33
    v_mov_b32 v33, v34
    s_nop 1
    v_permlane16_swap_b32 v33, v34
    v_add_f32 v34, v34, v33
    v_mul_f32 v34, 0x3b000000, v34
    v_cvt_pk_bf16_f32 v32, v32, v32
    v_and_b32 v32, 0xffff0000, v32
    v_cvt_pk_bf16_f32 v34, v34, v34
    v_and_b32 v34, 0xffff0000, v34
    v_add_f32 v34, 0x3727c5ac, v34
    v_cvt_pk_bf16_f32 v34, v34, v34
    v_and_b32 v34, 0xffff0000, v34
    v_sqrt_f32 v34, v34
    s_nop 0
    v_cvt_pk_bf16_f32 v34, v34, v34
    v_and_b32 v34, 0xffff0000, v34
    v_rcp_f32 v34, v34
    v_sub_f32 v16, v16, v32
    v_sub_f32 v17, v17, v32
    v_cvt_pk_bf16_f32 v33, v16, v17
    v_lshlrev_b32 v16, 16, v33
    v_and_b32 v17, 0xffff0000, v33
    v_mul_f32 v16, v16, v34
    v_mul_f32 v17, v17, v34
    v_cvt_pk_bf16_f32 v8, v16, v17
    v_sub_f32 v18, v18, v32
    v_sub_f32 v19, v19, v32
    v_cvt_pk_bf16_f32 v33, v18, v19
    v_lshlrev_b32 v18, 16, v33
    v_and_b32 v19, 0xffff0000, v33
    v_mul_f32 v18, v18, v34
    v_mul_f32 v19, v19, v34
    v_cvt_pk_bf16_f32 v9, v18, v19
    v_sub_f32 v20, v20, v32
    v_sub_f32 v21, v21, v32
    v_cvt_pk_bf16_f32 v33, v20, v21
    v_lshlrev_b32 v20, 16, v33
    v_and_b32 v21, 0xffff0000, v33
    v_mul_f32 v20, v20, v34
    v_mul_f32 v21, v21, v34
    v_cvt_pk_bf16_f32 v10, v20, v21
    v_sub_f32 v22, v22, v32
    v_sub_f32 v23, v23, v32
    v_cvt_pk_bf16_f32 v33, v22, v23
    v_lshlrev_b32 v22, 16, v33
    v_and_b32 v23, 0xffff0000, v33
    v_mul_f32 v22, v22, v34
    v_mul_f32 v23, v23, v34
    v_cvt_pk_bf16_f32 v11, v22, v23
    v_sub_f32 v24, v24, v32
    v_sub_f32 v25, v25, v32
    v_cvt_pk_bf16_f32 v33, v24, v25
    v_lshlrev_b32 v24, 16, v33
    v_and_b32 v25, 0xffff0000, v33
    v_mul_f32 v24, v24, v34
    v_mul_f32 v25, v25, v34
    v_cvt_pk_bf16_f32 v12, v24, v25
    v_sub_f32 v26, v26, v32
    v_sub_f32 v27, v27, v32
    v_cvt_pk_bf16_f32 v33, v26, v27
    v_lshlrev_b32 v26, 16, v33
    v_and_b32 v27, 0xffff0000, v33
    v_mul_f32 v26, v26, v34
    v_mul_f32 v27, v27, v34
    v_cvt_pk_bf16_f32 v13, v26, v27
    v_sub_f32 v28, v28, v32
    v_sub_f32 v29, v29, v32
    v_cvt_pk_bf16_f32 v33, v28, v29
    v_lshlrev_b32 v28, 16, v33
    v_and_b32 v29, 0xffff0000, v33
    v_mul_f32 v28, v28, v34
    v_mul_f32 v29, v29, v34
    v_cvt_pk_bf16_f32 v14, v28, v29
    v_sub_f32 v30, v30, v32
    v_sub_f32 v31, v31, v32
    v_cvt_pk_bf16_f32 v33, v30, v31
    v_lshlrev_b32 v30, 16, v33
    v_and_b32 v31, 0xffff0000, v33
    v_mul_f32 v30, v30, v34
    v_mul_f32 v31, v31, v34
    v_cvt_pk_bf16_f32 v15, v30, v31
    v_mov_b32 v40, 0
    v_mov_b32 v41, 0
    v_mov_b32 v42, 0
    v_mov_b32 v43, 0
    v_mov_b32 v44, 0
    v_mov_b32 v45, 0
    v_mov_b32 v46, 0
    v_mov_b32 v47, 0
    s_waitcnt vmcnt(14)
    v_perm_b32 v16, v68, v64, s44
    v_perm_b32 v17, v68, v64, s45
    v_perm_b32 v18, v69, v65, s44
    v_perm_b32 v19, v69, v65, s45
    v_perm_b32 v20, v70, v66, s44
    v_perm_b32 v21, v70, v66, s45
    v_perm_b32 v22, v71, v67, s44
    v_perm_b32 v23, v71, v67, s45
    v_dot2c_f32_bf16 v40, v8, v16
    v_dot2c_f32_bf16 v41, v8, v17
    v_dot2c_f32_bf16 v42, v8, v18
    v_dot2c_f32_bf16 v43, v8, v19
    v_dot2c_f32_bf16 v44, v8, v20
    v_dot2c_f32_bf16 v45, v8, v21
    v_dot2c_f32_bf16 v46, v8, v22
    v_dot2c_f32_bf16 v47, v8, v23
    s_waitcnt vmcnt(12)
    v_perm_b32 v24, v76, v72, s44
    v_perm_b32 v25, v76, v72, s45
    v_perm_b32 v26, v77, v73, s44
    v_perm_b32 v27, v77, v73, s45
    v_perm_b32 v28, v78, v74, s44
    v_perm_b32 v29, v78, v74, s45
    v_perm_b32 v30, v79, v75, s44
    v_perm_b32 v31, v79, v75, s45
    v_dot2c_f32_bf16 v40, v9, v24
    v_dot2c_f32_bf16 v41, v9, v25
    v_dot2c_f32_bf16 v42, v9, v26
    v_dot2c_f32_bf16 v43, v9, v27
    v_dot2c_f32_bf16 v44, v9, v28
    v_dot2c_f32_bf16 v45, v9, v29
    v_dot2c_f32_bf16 v46, v9, v30
    v_dot2c_f32_bf16 v47, v9, v31
    s_waitcnt vmcnt(10)
    v_perm_b32 v16, v84, v80, s44
    v_perm_b32 v17, v84, v80, s45
    v_perm_b32 v18, v85, v81, s44
    v_perm_b32 v19, v85, v81, s45
    v_perm_b32 v20, v86, v82, s44
    v_perm_b32 v21, v86, v82, s45
    v_perm_b32 v22, v87, v83, s44
    v_perm_b32 v23, v87, v83, s45
    v_dot2c_f32_bf16 v40, v10, v16
    v_dot2c_f32_bf16 v41, v10, v17
    v_dot2c_f32_bf16 v42, v10, v18
    v_dot2c_f32_bf16 v43, v10, v19
    v_dot2c_f32_bf16 v44, v10, v20
    v_dot2c_f32_bf16 v45, v10, v21
    v_dot2c_f32_bf16 v46, v10, v22
    v_dot2c_f32_bf16 v47, v10, v23
    s_waitcnt vmcnt(8)
    v_perm_b32 v24, v92, v88, s44
    v_perm_b32 v25, v92, v88, s45
    v_perm_b32 v26, v93, v89, s44
    v_perm_b32 v27, v93, v89, s45
    v_perm_b32 v28, v94, v90, s44
    v_perm_b32 v29, v94, v90, s45
    v_perm_b32 v30, v95, v91, s44
    v_perm_b32 v31, v95, v91, s45
    v_dot2c_f32_bf16 v40, v11, v24
    v_dot2c_f32_bf16 v41, v11, v25
    v_dot2c_f32_bf16 v42, v11, v26
    v_dot2c_f32_bf16 v43, v11, v27
    v_dot2c_f32_bf16 v44, v11, v28
    v_dot2c_f32_bf16 v45, v11, v29
    v_dot2c_f32_bf16 v46, v11, v30
    v_dot2c_f32_bf16 v47, v11, v31
    s_waitcnt vmcnt(6)
    v_perm_b32 v16, v100, v96, s44
    v_perm_b32 v17, v100, v96, s45
    v_perm_b32 v18, v101, v97, s44
    v_perm_b32 v19, v101, v97, s45
    v_perm_b32 v20, v102, v98, s44
    v_perm_b32 v21, v102, v98, s45
    v_perm_b32 v22, v103, v99, s44
    v_perm_b32 v23, v103, v99, s45
    v_dot2c_f32_bf16 v40, v12, v16
    v_dot2c_f32_bf16 v41, v12, v17
    v_dot2c_f32_bf16 v42, v12, v18
    v_dot2c_f32_bf16 v43, v12, v19
    v_dot2c_f32_bf16 v44, v12, v20
    v_dot2c_f32_bf16 v45, v12, v21
    v_dot2c_f32_bf16 v46, v12, v22
    v_dot2c_f32_bf16 v47, v12, v23
    s_waitcnt vmcnt(4)
    v_perm_b32 v24, v108, v104, s44
    v_perm_b32 v25, v108, v104, s45
    v_perm_b32 v26, v109, v105, s44
    v_perm_b32 v27, v109, v105, s45
    v_perm_b32 v28, v110, v106, s44
    v_perm_b32 v29, v110, v106, s45
    v_perm_b32 v30, v111, v107, s44
    v_perm_b32 v31, v111, v107, s45
    v_dot2c_f32_bf16 v40, v13, v24
    v_dot2c_f32_bf16 v41, v13, v25
    v_dot2c_f32_bf16 v42, v13, v26
    v_dot2c_f32_bf16 v43, v13, v27
    v_dot2c_f32_bf16 v44, v13, v28
    v_dot2c_f32_bf16 v45, v13, v29
    v_dot2c_f32_bf16 v46, v13, v30
    v_dot2c_f32_bf16 v47, v13, v31
    s_waitcnt vmcnt(2)
    v_perm_b32 v16, v116, v112, s44
    v_perm_b32 v17, v116, v112, s45
    v_perm_b32 v18, v117, v113, s44
    v_perm_b32 v19, v117, v113, s45
    v_perm_b32 v20, v118, v114, s44
    v_perm_b32 v21, v118, v114, s45
    v_perm_b32 v22, v119, v115, s44
    v_perm_b32 v23, v119, v115, s45
    v_dot2c_f32_bf16 v40, v14, v16
    v_dot2c_f32_bf16 v41, v14, v17
    v_dot2c_f32_bf16 v42, v14, v18
    v_dot2c_f32_bf16 v43, v14, v19
    v_dot2c_f32_bf16 v44, v14, v20
    v_dot2c_f32_bf16 v45, v14, v21
    v_dot2c_f32_bf16 v46, v14, v22
    v_dot2c_f32_bf16 v47, v14, v23
    s_waitcnt vmcnt(0)
    v_perm_b32 v24, v124, v120, s44
    v_perm_b32 v25, v124, v120, s45
    v_perm_b32 v26, v125, v121, s44
    v_perm_b32 v27, v125, v121, s45
    v_perm_b32 v28, v126, v122, s44
    v_perm_b32 v29, v126, v122, s45
    v_perm_b32 v30, v127, v123, s44
    v_perm_b32 v31, v127, v123, s45
    v_dot2c_f32_bf16 v40, v15, v24
    v_dot2c_f32_bf16 v41, v15, v25
    v_dot2c_f32_bf16 v42, v15, v26
    v_dot2c_f32_bf16 v43, v15, v27
    v_dot2c_f32_bf16 v44, v15, v28
    v_dot2c_f32_bf16 v45, v15, v29
    v_dot2c_f32_bf16 v46, v15, v30
    v_dot2c_f32_bf16 v47, v15, v31
    v_permlane32_swap_b32 v40, v44
    v_permlane32_swap_b32 v41, v45
    v_permlane32_swap_b32 v42, v46
    v_permlane32_swap_b32 v43, v47
    v_add_f32 v40, v40, v44
    v_add_f32 v41, v41, v45
    v_add_f32 v42, v42, v46
    v_add_f32 v43, v43, v47
    s_nop 0
    v_permlane16_swap_b32 v40, v42
    v_permlane16_swap_b32 v41, v43
    v_add_f32 v40, v40, v42
    v_add_f32 v41, v41, v43
    s_nop 0
    v_add_f32_dpp v40, v40, v40 quad_perm:[2,3,0,1] row_mask:0xf bank_mask:0xf
    v_add_f32_dpp v41, v41, v41 quad_perm:[2,3,0,1] row_mask:0xf bank_mask:0xf
    s_nop 0
    v_add_f32_dpp v40, v40, v40 row_ror:4 row_mask:0xf bank_mask:0xf
    v_add_f32_dpp v41, v41, v41 row_ror:4 row_mask:0xf bank_mask:0xf
    s_nop 0
    v_add_f32_dpp v40, v40, v40 row_ror:8 row_mask:0xf bank_mask:0xf
    v_add_f32_dpp v41, v41, v41 row_ror:8 row_mask:0xf bank_mask:0xf
    v_cvt_pk_bf16_f32 v40, v40, v41
    ds_write_b32 v6, v40 offset:1088
    ds_read_b64 v[44:45], v37 offset:1088
    s_waitcnt lgkmcnt(0)
    s_add_u32 s23, s23, 0x9e3779b9
    s_or_b32 s23, s23, 1
    v_mov_b32 v7, s23
    v_mov_b32 v46, v45
    v_mov_b32 v45, s23
    v_mov_b32 v47, s23
    s_mov_b64 exec, 0xf
    buffer_store_dwordx4 v[44:47], v38, s[36:39], s41 offen sc1
    s_mov_b64 exec, -1
    v_lshlrev_b32 v6, 4, v0
    s_mov_b32 s46, 200000
L_poll0:
    buffer_load_dwordx4 v[48:51], v6, s[36:39], s40 offen sc1
    buffer_load_dwordx4 v[52:55], v6, s[36:39], s40 offen offset:1024 sc1
    s_waitcnt vmcnt(0)
    v_mov_b32 v56, v7
    v_mov_b32 v57, v7
    v_min3_u32 v56, v56, v49, v51
    v_max3_u32 v57, v57, v49, v51
    v_min3_u32 v56, v56, v53, v55
    v_max3_u32 v57, v57, v53, v55
    v_cmp_ne_u32 vcc, v56, v57
    s_cbranch_vccz L_pdone0
    s_sub_u32 s46, s46, 1
    s_cbranch_scc1 L_pdone0
    s_sleep 1
    s_branch L_poll0
L_pdone0:
    v_lshlrev_b32 v2, 3, v0
    ds_write2_b32 v2, v48, v50 offset0:0 offset1:1
    ds_write2_b32 v2, v52, v54 offset0:128 offset1:129
    v_mov_b32 v2, 1024
    v_mov_b32 v36, 24
    ds_write2_b32 v2, v7, v36 offset0:0 offset1:1
    v_mov_b32 v36, 0
    ds_write_b32 v2, v36 offset:12
    s_waitcnt lgkmcnt(0)
    s_barrier
    s_and_b32 s40, s43, 7
    s_mul_i32 s40, s40, 128
    s_lshr_b32 s41, s43, 3
    s_lshl_b32 s41, s41, 2
    s_add_u32 s40, s40, s41
    v_and_b32 v62, 7, v0
    v_lshlrev_b32 v62, 4, v62
    v_add_u32 v62, s40, v62
    buffer_load_dword v63, v62, s[28:31], 0 offen
    v_mov_b32 v39, 0
    s_mov_b32 s94, 0
    s_cmp_ge_u32 s27, 14
    s_cbranch_scc1 L_noffn
    s_lshl3_add_u32 s22, s27, s26
    s_lshl_b32 s42, s22, 4
    s_lshl_b32 s40, s42, 1
    s_sub_u32 s41, 1835008, s40
    s_add_u32 s32, s16, s40
    s_addc_u32 s33, s17, 0
    s_mov_b32 s34, s41
    s_mov_b32 s35, 0x20000
    s_mov_b32 s47, 0
    buffer_load_dwordx4 v[64:67], v3, s[32:35], s47 offen nt
    s_addk_i32 s47, 3584
    buffer_load_dwordx4 v[68:71], v3, s[32:35], s47 offen nt
    s_addk_i32 s47, 3584
    buffer_load_dwordx4 v[72:75], v3, s[32:35], s47 offen nt
    s_addk_i32 s47, 3584
    buffer_load_dwordx4 v[76:79], v3, s[32:35], s47 offen nt
    s_addk_i32 s47, 3584
    buffer_load_dwordx4 v[80:83], v3, s[32:35], s47 offen nt
    s_addk_i32 s47, 3584
    buffer_load_dwordx4 v[84:87], v3, s[32:35], s47 offen nt
    s_addk_i32 s47, 3584
    buffer_load_dwordx4 v[88:91], v3, s[32:35], s47 offen nt
    s_addk_i32 s47, 3584
    buffer_load_dwordx4 v[92:95], v3, s[32:35], s47 offen nt
    s_addk_i32 s47, 3584
    buffer_load_dwordx4 v[96:99], v3, s[32:35], s47 offen nt
    s_addk_i32 s47, 3584
    buffer_load_dwordx4 v[100:103], v3, s[32:35], s47 offen nt
    s_addk_i32 s47, 3584
    buffer_load_dwordx4 v[104:107], v3, s[32:35], s47 offen nt
    s_addk_i32 s47, 3584
    buffer_load_dwordx4 v[108:111], v3, s[32:35], s47 offen nt
    s_addk_i32 s47, 3584
    buffer_load_dwordx4 v[112:115], v3, s[32:35], s47 offen nt
    s_addk_i32 s47, 3584
    buffer_load_dwordx4 v[116:119], v3, s[32:35], s47 offen nt
    s_addk_i32 s47, 3584
    buffer_load_dwordx4 v[120:123], v3, s[32:35], s47 offen nt
    s_addk_i32 s47, 3584
    buffer_load_dwordx4 v[124:127], v3, s[32:35], s47 offen nt
    s_lshl_b32 s40, s42, 10
    s_add_u32 s28, s18, s40
    s_addc_u32 s29, s19, 0
    s_mov_b32 s30, 16384
    s_mov_b32 s31, 0x20000
    v_lshrrev_b32 v5, 3, v0
    v_mul_u32_u24 v5, 16384, v5
    v_and_b32 v4, 7, v0
    v_lshl_add_u32 v5, v4, 4, v5
    s_mul_i32 s56, s22, 128
    s_add_u32 s56, s56, 65536
    s_add_u32 s57, s56, 131072
    s_add_u32 s58, s56, 262144
    s_add_u32 s59, s56, 393216
    v_mov_b32 v40, 0
    v_mov_b32 v41, 0
    v_mov_b32 v42, 0
    v_mov_b32 v43, 0
    v_mov_b32 v44, 0
    v_mov_b32 v45, 0
    v_mov_b32 v46, 0
    v_mov_b32 v47, 0
    s_waitcnt vmcnt(14)
    v_perm_b32 v16, v68, v64, s44
    v_perm_b32 v17, v68, v64, s45
    v_perm_b32 v18, v69, v65, s44
    v_perm_b32 v19, v69, v65, s45
    v_perm_b32 v20, v70, v66, s44
    v_perm_b32 v21, v70, v66, s45
    v_perm_b32 v22, v71, v67, s44
    v_perm_b32 v23, v71, v67, s45
    v_dot2c_f32_bf16 v40, v8, v16
    v_dot2c_f32_bf16 v41, v8, v17
    v_dot2c_f32_bf16 v42, v8, v18
    v_dot2c_f32_bf16 v43, v8, v19
    v_dot2c_f32_bf16 v44, v8, v20
    v_dot2c_f32_bf16 v45, v8, v21
    v_dot2c_f32_bf16 v46, v8, v22
    v_dot2c_f32_bf16 v47, v8, v23
    s_waitcnt vmcnt(12)
    v_perm_b32 v24, v76, v72, s44
    v_perm_b32 v25, v76, v72, s45
    v_perm_b32 v26, v77, v73, s44
    v_perm_b32 v27, v77, v73, s45
    v_perm_b32 v28, v78, v74, s44
    v_perm_b32 v29, v78, v74, s45
    v_perm_b32 v30, v79, v75, s44
    v_perm_b32 v31, v79, v75, s45
    v_dot2c_f32_bf16 v40, v9, v24
    v_dot2c_f32_bf16 v41, v9, v25
    v_dot2c_f32_bf16 v42, v9, v26
    v_dot2c_f32_bf16 v43, v9, v27
    v_dot2c_f32_bf16 v44, v9, v28
    v_dot2c_f32_bf16 v45, v9, v29
    v_dot2c_f32_bf16 v46, v9, v30
    v_dot2c_f32_bf16 v47, v9, v31
    s_waitcnt vmcnt(10)
    v_perm_b32 v16, v84, v80, s44
    v_perm_b32 v17, v84, v80, s45
    v_perm_b32 v18, v85, v81, s44
    v_perm_b32 v19, v85, v81, s45
    v_perm_b32 v20, v86, v82, s44
    v_perm_b32 v21, v86, v82, s45
    v_perm_b32 v22, v87, v83, s44
    v_perm_b32 v23, v87, v83, s45
    v_dot2c_f32_bf16 v40, v10, v16
    v_dot2c_f32_bf16 v41, v10, v17
    v_dot2c_f32_bf16 v42, v10, v18
    v_dot2c_f32_bf16 v43, v10, v19
    v_dot2c_f32_bf16 v44, v10, v20
    v_dot2c_f32_bf16 v45, v10, v21
    v_dot2c_f32_bf16 v46, v10, v22
    v_dot2c_f32_bf16 v47, v10, v23
    s_waitcnt vmcnt(8)
    v_perm_b32 v24, v92, v88, s44
    v_perm_b32 v25, v92, v88, s45
    v_perm_b32 v26, v93, v89, s44
    v_perm_b32 v27, v93, v89, s45
    v_perm_b32 v28, v94, v90, s44
    v_perm_b32 v29, v94, v90, s45
    v_perm_b32 v30, v95, v91, s44
    v_perm_b32 v31, v95, v91, s45
    v_dot2c_f32_bf16 v40, v11, v24
    v_dot2c_f32_bf16 v41, v11, v25
    v_dot2c_f32_bf16 v42, v11, v26
    v_dot2c_f32_bf16 v43, v11, v27
    v_dot2c_f32_bf16 v44, v11, v28
    v_dot2c_f32_bf16 v45, v11, v29
    v_dot2c_f32_bf16 v46, v11, v30
    v_dot2c_f32_bf16 v47, v11, v31
    s_waitcnt vmcnt(6)
    v_perm_b32 v16, v100, v96, s44
    v_perm_b32 v17, v100, v96, s45
    v_perm_b32 v18, v101, v97, s44
    v_perm_b32 v19, v101, v97, s45
    v_perm_b32 v20, v102, v98, s44
    v_perm_b32 v21, v102, v98, s45
    v_perm_b32 v22, v103, v99, s44
    v_perm_b32 v23, v103, v99, s45
    v_dot2c_f32_bf16 v40, v12, v16
    v_dot2c_f32_bf16 v41, v12, v17
    v_dot2c_f32_bf16 v42, v12, v18
    v_dot2c_f32_bf16 v43, v12, v19
    v_dot2c_f32_bf16 v44, v12, v20
    v_dot2c_f32_bf16 v45, v12, v21
    v_dot2c_f32_bf16 v46, v12, v22
    v_dot2c_f32_bf16 v47, v12, v23
    s_waitcnt vmcnt(4)
    v_perm_b32 v24, v108, v104, s44
    v_perm_b32 v25, v108, v104, s45
    v_perm_b32 v26, v109, v105, s44
    v_perm_b32 v27, v109, v105, s45
    v_perm_b32 v28, v110, v106, s44
    v_perm_b32 v29, v110, v106, s45
    v_perm_b32 v30, v111, v107, s44
    v_perm_b32 v31, v111, v107, s45
    v_dot2c_f32_bf16 v40, v13, v24
    v_dot2c_f32_bf16 v41, v13, v25
    v_dot2c_f32_bf16 v42, v13, v26
    v_dot2c_f32_bf16 v43, v13, v27
    v_dot2c_f32_bf16 v44, v13, v28
    v_dot2c_f32_bf16 v45, v13, v29
    v_dot2c_f32_bf16 v46, v13, v30
    v_dot2c_f32_bf16 v47, v13, v31
    s_waitcnt vmcnt(2)
    v_perm_b32 v16, v116, v112, s44
    v_perm_b32 v17, v116, v112, s45
    v_perm_b32 v18, v117, v113, s44
    v_perm_b32 v19, v117, v113, s45
    v_perm_b32 v20, v118, v114, s44
    v_perm_b32 v21, v118, v114, s45
    v_perm_b32 v22, v119, v115, s44
    v_perm_b32 v23, v119, v115, s45
    v_dot2c_f32_bf16 v40, v14, v16
    v_dot2c_f32_bf16 v41, v14, v17
    v_dot2c_f32_bf16 v42, v14, v18
    v_dot2c_f32_bf16 v43, v14, v19
    v_dot2c_f32_bf16 v44, v14, v20
    v_dot2c_f32_bf16 v45, v14, v21
    v_dot2c_f32_bf16 v46, v14, v22
    v_dot2c_f32_bf16 v47, v14, v23
    s_waitcnt vmcnt(0)
    v_perm_b32 v24, v124, v120, s44
    v_perm_b32 v25, v124, v120, s45
    v_perm_b32 v26, v125, v121, s44
    v_perm_b32 v27, v125, v121, s45
    v_perm_b32 v28, v126, v122, s44
    v_perm_b32 v29, v126, v122, s45
    v_perm_b32 v30, v127, v123, s44
    v_perm_b32 v31, v127, v123, s45
    v_dot2c_f32_bf16 v40, v15, v24
    v_dot2c_f32_bf16 v41, v15, v25
    v_dot2c_f32_bf16 v42, v15, v26
    v_dot2c_f32_bf16 v43, v15, v27
    v_dot2c_f32_bf16 v44, v15, v28
    v_dot2c_f32_bf16 v45, v15, v29
    v_dot2c_f32_bf16 v46, v15, v30
    v_dot2c_f32_bf16 v47, v15, v31
    v_permlane32_swap_b32 v40, v44
    v_permlane32_swap_b32 v41, v45
    v_permlane32_swap_b32 v42, v46
    v_permlane32_swap_b32 v43, v47
    v_add_f32 v40, v40, v44
    v_add_f32 v41, v41, v45
    v_add_f32 v42, v42, v46
    v_add_f32 v43, v43, v47
    s_nop 0
    v_permlane16_swap_b32 v40, v42
    v_permlane16_swap_b32 v41, v43
    v_add_f32 v40, v40, v42
    v_add_f32 v41, v41, v43
    s_nop 0
    v_add_f32_dpp v40, v40, v40 quad_perm:[2,3,0,1] row_mask:0xf bank_mask:0xf
    v_add_f32_dpp v41, v41, v41 quad_perm:[2,3,0,1] row_mask:0xf bank_mask:0xf
    s_nop 0
    v_add_f32_dpp v40, v40, v40 row_ror:4 row_mask:0xf bank_mask:0xf
    v_add_f32_dpp v41, v41, v41 row_ror:4 row_mask:0xf bank_mask:0xf
    s_nop 0
    v_add_f32_dpp v40, v40, v40 row_ror:8 row_mask:0xf bank_mask:0xf
    v_add_f32_dpp v41, v41, v41 row_ror:8 row_mask:0xf bank_mask:0xf
    v_max_f32 v40, 0, v40
    v_max_f32 v41, 0, v41
    v_cvt_pk_bf16_f32 v38, v40, v41
    v_mov_b32 v39, v5
    s_mov_b32 s80, s56
    s_mov_b32 s81, s57
    s_mov_b32 s82, s58
    s_mov_b32 s83, s59
    s_mov_b32 s94, 1
    s_branch L_gc
L_gcdry:
    s_mov_b32 s94, 0
    v_mov_b32 v240, 0
    v_mov_b32 v241, v7
    v_mov_b32 v242, 0
    v_mov_b32 v243, v7
    v_mov_b32 v244, 0
    v_mov_b32 v245, v7
    v_mov_b32 v246, 0
    v_mov_b32 v247, v7
    v_mov_b32 v248, 0
    v_mov_b32 v249, v7
    v_mov_b32 v250, 0
    v_mov_b32 v251, v7
    v_mov_b32 v252, 0
    v_mov_b32 v253, v7
    v_mov_b32 v254, 0
    v_mov_b32 v255, v7
L_noffn:
    s_lshl_b32 s40, s26, 19
    s_lshl_b32 s41, s27, 14
    s_add_u32 s40, s40, s41
    s_add_u32 s76, s12, s40
    s_addc_u32 s77, s13, 0
    s_mov_b32 s78, 16384
    s_mov_b32 s79, 0x20000
    v_lshrrev_b32 v5, 3, v0
    v_mul_u32_u24 v5, 32768, v5
    v_and_b32 v4, 7, v0
    v_lshl_add_u32 v5, v4, 4, v5
    s_mul_i32 s56, s2, 128
    s_add_u32 s56, s56, 2097152
    s_add_u32 s57, s56, 262144
    s_add_u32 s58, s56, 524288
    s_add_u32 s59, s56, 786432
    s_cmp_lt_u32 s27, 16
    s_addc_u32 s41, 115, 0
    s_cmp_lt_u32 s27, 14
    s_cmovk_i32 s41, 108
    s_sub_u32 s42, s41, 24
    v_mov_b32 v40, 1028
    s_mul_i32 s40, s26, 4096
    s_add_u32 s40, s40, 5242880
    s_mul_i32 s47, s27, 128
    s_add_u32 s47, s47, s40
L_rw:
    s_sleep 2
    ds_read_b32 v41, v40
    s_memrealtime s[48:49]
    s_waitcnt lgkmcnt(0)
    v_readfirstlane_b32 s50, v41
    s_sub_u32 s48, s48, s86
    s_cmp_ge_u32 s50, s42
    s_cbranch_scc1 L_rgo
    s_cmp_lt_u32 s48, 2750
    s_cbranch_scc1 L_rw
    s_add_u32 s49, s50, 1
    s_min_u32 s42, s42, s49
    s_cmp_lt_u32 s48, 0x100000
    s_cbranch_scc1 L_rw
L_rgo:
    s_sub_u32 s50, s41, s50
    s_mul_i32 s50, s50, 28
    s_add_u32 s48, s48, s50
    s_cmp_lt_u32 s27, 14
    s_cselect_b32 s50, 20, 0
    s_add_u32 s48, s48, s50
    v_mov_b32 v42, s48
    v_mov_b32 v43, v7
    v_add_u32 v42, s86, v42
    v_and_b32 v42, 0xffffff, v42
    v_lshlrev_b32 v44, 3, v0
    v_mov_b32 v45, s48
    v_and_b32 v46, 1, v0
    v_cmp_eq_u32 vcc, 1, v46
    s_nop 1
    v_cndmask_b32 v42, v42, v45, vcc
    s_mov_b64 exec, 0xffff
    buffer_store_dwordx2 v[42:43], v44, s[36:39], s47 offen sc1
    s_mov_b64 exec, -1
    s_sub_u32 s42, s41, 10
L_rd:
    s_sleep 2
    ds_read_b32 v41, v40
    s_waitcnt lgkmcnt(0)
    v_cmp_gt_u32 vcc, s42, v41
    s_cbranch_vccnz L_rd
    v_and_b32 v44, 31, v0
    v_mul_u32_u24 v44, 128, v44
    s_mov_b32 s46, 200000
L_poll1:
    buffer_load_dwordx4 v[46:49], v44, s[36:39], s40 offen sc1
    s_waitcnt vmcnt(0)
    v_mov_b32 v56, v7
    v_mov_b32 v57, v7
    v_min3_u32 v56, v56, v47, v49
    v_max3_u32 v57, v57, v47, v49
    v_cmp_ne_u32 vcc, v56, v57
    s_cbranch_vccz L_pdone1
    s_sub_u32 s46, s46, 1
    s_cbranch_scc1 L_pdone1
    s_sleep 1
    s_branch L_poll1
L_pdone1:
L_rskip:
    v_readfirstlane_b32 s48, v46
    s_sub_u32 s48, s48, 0x10000
    s_nop 0
    v_subrev_u32 v46, s48, v46
    v_and_b32 v46, 0xffffff, v46
    v_mov_b32 v50, v48
    v_mov_b32 v48, v46
    s_nop 1
    v_add_u32_dpp v48, v48, v48 quad_perm:[1,0,3,2] row_mask:0xf bank_mask:0xf
    v_add_u32_dpp v50, v50, v50 quad_perm:[1,0,3,2] row_mask:0xf bank_mask:0xf
    s_nop 0
    v_add_u32_dpp v48, v48, v48 quad_perm:[2,3,0,1] row_mask:0xf bank_mask:0xf
    v_add_u32_dpp v50, v50, v50 quad_perm:[2,3,0,1] row_mask:0xf bank_mask:0xf
    s_nop 0
    v_add_u32_dpp v48, v48, v48 row_ror:4 row_mask:0xf bank_mask:0xf
    v_add_u32_dpp v50, v50, v50 row_ror:4 row_mask:0xf bank_mask:0xf
    s_nop 0
    v_add_u32_dpp v48, v48, v48 row_ror:8 row_mask:0xf bank_mask:0xf
    v_add_u32_dpp v50, v50, v50 row_ror:8 row_mask:0xf bank_mask:0xf
    v_mov_b32 v49, v48
    v_mov_b32 v51, v50
    s_nop 0
    v_permlane32_swap_b32 v49, v48
    v_permlane32_swap_b32 v51, v50
    v_add_u32 v48, v48, v49
    v_add_u32 v50, v50, v51
    v_mov_b32 v49, v48
    v_mov_b32 v51, v50
    s_nop 0
    v_permlane16_swap_b32 v49, v48
    v_permlane16_swap_b32 v51, v50
    v_add_u32 v48, v48, v49
    v_add_u32 v50, v50, v51
    v_lshrrev_b32 v48, 6, v48
    s_nop 0
    v_readfirstlane_b32 s92, v48
    s_add_u32 s92, s92, s48
    s_add_u32 s92, s92, 755
    v_readfirstlane_b32 s93, v50
    s_sub_u32 s93, s93, 203520
    s_mul_i32 s93, s93, 2
    s_ashr_i32 s93, s93, 8
    s_add_u32 s92, s92, s93
    v_sub_u32 v48, v48, v46
    v_add_u32 v48, 448, v48
    v_mov_b32 v49, 0x1000
    v_med3_i32 v48, v48, 1, v49
    v_cmp_gt_u32 vcc, 32, v0
    s_nop 1
    v_cndmask_b32 v48, 0, v48, vcc
    v_cmp_gt_u32 vcc, s27, v0
    s_nop 1
    v_cndmask_b32 v49, 0, v48, vcc
    v_cmp_ge_u32 vcc, s27, v0
    s_nop 1
    v_cndmask_b32 v50, 0, v48, vcc
    v_add_u32_dpp v48, v48, v48 quad_perm:[1,0,3,2] row_mask:0xf bank_mask:0xf
    v_add_u32_dpp v49, v49, v49 quad_perm:[1,0,3,2] row_mask:0xf bank_mask:0xf
    v_add_u32_dpp v50, v50, v50 quad_perm:[1,0,3,2] row_mask:0xf bank_mask:0xf
    v_add_u32_dpp v48, v48, v48 quad_perm:[2,3,0,1] row_mask:0xf bank_mask:0xf
    v_add_u32_dpp v49, v49, v49 quad_perm:[2,3,0,1] row_mask:0xf bank_mask:0xf
    v_add_u32_dpp v50, v50, v50 quad_perm:[2,3,0,1] row_mask:0xf bank_mask:0xf
    v_add_u32_dpp v48, v48, v48 row_ror:4 row_mask:0xf bank_mask:0xf
    v_add_u32_dpp v49, v49, v49 row_ror:4 row_mask:0xf bank_mask:0xf
    v_add_u32_dpp v50, v50, v50 row_ror:4 row_mask:0xf bank_mask:0xf
    v_add_u32_dpp v48, v48, v48 row_ror:8 row_mask:0xf bank_mask:0xf
    v_add_u32_dpp v49, v49, v49 row_ror:8 row_mask:0xf bank_mask:0xf
    v_add_u32_dpp v50, v50, v50 row_ror:8 row_mask:0xf bank_mask:0xf
    v_mov_b32 v51, v48
    v_mov_b32 v52, v49
    v_mov_b32 v53, v50
    v_permlane32_swap_b32 v51, v48
    v_permlane32_swap_b32 v52, v49
    v_permlane32_swap_b32 v53, v50
    v_add_u32 v48, v48, v51
    v_add_u32 v49, v49, v52
    v_add_u32 v50, v50, v53
    v_mov_b32 v51, v48
    v_mov_b32 v52, v49
    v_mov_b32 v53, v50
    v_permlane16_swap_b32 v51, v48
    v_permlane16_swap_b32 v52, v49
    v_permlane16_swap_b32 v53, v50
    v_add_u32 v48, v48, v51
    v_add_u32 v49, v49, v52
    v_add_u32 v50, v50, v53
    v_cvt_f32_u32 v48, v48
    v_cvt_f32_u32 v49, v49
    v_cvt_f32_u32 v50, v50
    v_rcp_f32 v48, v48
    s_nop 0
    v_mul_f32 v48, 0x44000000, v48
    v_mul_f32 v49, v49, v48
    v_mul_f32 v50, v50, v48
    v_cvt_u32_f32 v49, v49
    v_cvt_u32_f32 v50, v50
    v_readfirstlane_b32 s48, v49
    v_readfirstlane_b32 s49, v50
    s_min_u32 s48, s48, 512
    s_min_u32 s49, s49, 512
    s_cmp_eq_u32 s27, 31
    s_cselect_b32 s49, 512, s49
    s_sub_u32 s49, s49, s48
    s_add_u32 s49, s49, s41
    s_sub_u32 s48, s48, s41
    v_mov_b32 v42, s48
    v_mov_b32 v43, s49
    ds_write_b64 v40, v[42:43] offset:4
    s_lshl_b32 s40, s26, 17
    s_lshl_b32 s41, s27, 12
    s_add_u32 s40, s40, s41
    s_add_u32 s40, s40, 1048576
    s_lshl_b32 s41, s26, 11
    s_lshr_b32 s42, s27, 3
    s_lshl_b32 s42, s42, 9
    s_add_u32 s41, s41, s42
    s_add_u32 s41, s41, 32768
    v_lshrrev_b32 v3, 3, v0
    v_lshlrev_b32 v3, 4, v3
    s_mov_b32 s32, s20
    s_mov_b32 s33, s21
    s_mov_b32 s34, 1024
    s_mov_b32 s35, 0x20000
    v_mov_b32 v16, 0
    v_mov_b32 v17, v7
    v_mov_b32 v18, 0
    v_mov_b32 v19, v7
    v_mov_b32 v20, 0
    v_mov_b32 v21, v7
    v_mov_b32 v22, 0
    v_mov_b32 v23, v7
    v_mov_b32 v24, 0
    v_mov_b32 v25, v7
    v_mov_b32 v26, 0
    v_mov_b32 v27, v7
    v_mov_b32 v28, 0
    v_mov_b32 v29, v7
    v_mov_b32 v30, 0
    v_mov_b32 v31, v7
    v_mov_b32 v52, v6
    v_mov_b32 v53, v6
    v_mov_b32 v54, v6
    v_mov_b32 v55, v6
    v_bfrev_b32 v56, 1
    s_add_u32 s42, s49, 7
    s_mov_b32 s46, 800000
    v_readlane_b32 s48, v38, 0
    v_readlane_b32 s49, v38, 16
    v_readlane_b32 s50, v38, 32
    v_readlane_b32 s51, v38, 48
    v_readlane_b32 s52, v38, 1
    v_readlane_b32 s53, v38, 17
    v_readlane_b32 s54, v38, 33
    v_readlane_b32 s55, v38, 49
L_wl:
    s_sleep 1
    ds_read_b32 v41, v40
    s_sub_u32 s46, s46, 1
    s_cbranch_scc1 L_wld
    s_waitcnt lgkmcnt(0)
    v_cmp_gt_u32 vcc, s42, v41
    s_cbranch_vccnz L_wl
L_wld:
    s_cmp_ge_u32 s27, 14
    s_cbranch_scc1 L_now2
    s_movk_i32 s47, 0
    buffer_load_dwordx4 v[64:67], v6, s[28:31], s47 offen offset:0 nt
    buffer_load_dwordx4 v[68:71], v6, s[28:31], s47 offen offset:1024 nt
    buffer_load_dwordx4 v[72:75], v6, s[28:31], s47 offen offset:2048 nt
    buffer_load_dwordx4 v[76:79], v6, s[28:31], s47 offen offset:3072 nt
    s_movk_i32 s47, 4096
    buffer_load_dwordx4 v[80:83], v6, s[28:31], s47 offen offset:0 nt
    buffer_load_dwordx4 v[84:87], v6, s[28:31], s47 offen offset:1024 nt
    buffer_load_dwordx4 v[88:91], v6, s[28:31], s47 offen offset:2048 nt
    buffer_load_dwordx4 v[92:95], v6, s[28:31], s47 offen offset:3072 nt
    s_movk_i32 s47, 8192
    buffer_load_dwordx4 v[96:99], v6, s[28:31], s47 offen offset:0 nt
    buffer_load_dwordx4 v[100:103], v6, s[28:31], s47 offen offset:1024 nt
    buffer_load_dwordx4 v[104:107], v6, s[28:31], s47 offen offset:2048 nt
    buffer_load_dwordx4 v[108:111], v6, s[28:31], s47 offen offset:3072 nt
    s_movk_i32 s47, 12288
    buffer_load_dwordx4 v[112:115], v6, s[28:31], s47 offen offset:0 nt
    buffer_load_dwordx4 v[116:119], v6, s[28:31], s47 offen offset:1024 nt
    buffer_load_dwordx4 v[120:123], v6, s[28:31], s47 offen offset:2048 nt
    buffer_load_dwordx4 v[124:127], v6, s[28:31], s47 offen offset:3072 nt
L_now2:
    s_movk_i32 s47, 0
    buffer_load_dwordx4 v[136:139], v6, s[76:79], s47 offen offset:0 nt
    buffer_load_dwordx4 v[140:143], v6, s[76:79], s47 offen offset:1024 nt
    buffer_load_dwordx4 v[144:147], v6, s[76:79], s47 offen offset:2048 nt
    buffer_load_dwordx4 v[148:151], v6, s[76:79], s47 offen offset:3072 nt
    s_movk_i32 s47, 4096
    buffer_load_dwordx4 v[152:155], v6, s[76:79], s47 offen offset:0 nt
    buffer_load_dwordx4 v[156:159], v6, s[76:79], s47 offen offset:1024 nt
    buffer_load_dwordx4 v[160:163], v6, s[76:79], s47 offen offset:2048 nt
    buffer_load_dwordx4 v[164:167], v6, s[76:79], s47 offen offset:3072 nt
    s_movk_i32 s47, 8192
    buffer_load_dwordx4 v[168:171], v6, s[76:79], s47 offen offset:0 nt
    buffer_load_dwordx4 v[172:175], v6, s[76:79], s47 offen offset:1024 nt
    buffer_load_dwordx4 v[176:179], v6, s[76:79], s47 offen offset:2048 nt
    buffer_load_dwordx4 v[180:183], v6, s[76:79], s47 offen offset:3072 nt
    s_movk_i32 s47, 12288
    buffer_load_dwordx4 v[184:187], v6, s[76:79], s47 offen offset:0 nt
    buffer_load_dwordx4 v[188:191], v6, s[76:79], s47 offen offset:1024 nt
    buffer_load_dwordx4 v[192:195], v6, s[76:79], s47 offen offset:2048 nt
    buffer_load_dwordx4 v[196:199], v6, s[76:79], s47 offen offset:3072 nt
    s_branch L_tail
L_backlog:
    v_mfma_f32_16x16x32_bf16 v[32:35], v[64:67], v[16:19], 0
    v_mfma_f32_16x16x32_bf16 v[32:35], v[68:71], v[20:23], v[32:35]
    v_mfma_f32_16x16x32_bf16 v[32:35], v[72:75], v[24:27], v[32:35]
    v_mfma_f32_16x16x32_bf16 v[32:35], v[76:79], v[28:31], v[32:35]
    s_nop 7
    v_max3_f32 v49, v32, v33, v34
    v_max_f32 v49, v49, v35
    v_cmp_gt_f32 vcc, v49, v44
    s_cbranch_vccz L_skip0
    v_mov_b32 v50, v49
    s_nop 1
    v_permlane32_swap_b32 v50, v49
    v_max_f32 v49, v49, v50
    v_mov_b32 v50, v49
    s_nop 1
    v_permlane16_swap_b32 v50, v49
    v_max_f32 v49, v49, v50
    v_max_f32 v49, v49, v44
    v_sub_f32 v50, v44, v49
    v_mul_f32 v50, s44, v50
    v_exp_f32 v50, v50
    v_mov_b32 v44, v49
    v_mul_f32 v45, s44, v49
    v_mul_f32 v46, v46, v50
    v_mul_f32 v36, v36, v50
    v_mul_f32 v37, v37, v50
    v_mul_f32 v38, v38, v50
    v_mul_f32 v39, v39, v50
    v_mul_f32 v40, v40, v50
    v_mul_f32 v41, v41, v50
    v_mul_f32 v42, v42, v50
    v_mul_f32 v43, v43, v50
L_skip0:
    v_fma_f32 v32, v32, s44, -v45
    v_fma_f32 v33, v33, s44, -v45
    v_fma_f32 v34, v34, s44, -v45
    v_fma_f32 v35, v35, s44, -v45
    v_exp_f32 v32, v32
    v_exp_f32 v33, v33
    v_exp_f32 v34, v34
    v_exp_f32 v35, v35
    v_cvt_pk_bf16_f32 v49, v32, v32
    v_cvt_pk_bf16_f32 v50, v33, v33
    v_cvt_pk_bf16_f32 v51, v34, v34
    v_cvt_pk_bf16_f32 v52, v35, v35
    v_and_b32 v54, v49, v47
    v_and_b32 v55, v49, v48
    v_and_b32 v56, v50, v47
    v_and_b32 v57, v50, v48
    v_and_b32 v58, v51, v47
    v_and_b32 v59, v51, v48
    v_and_b32 v60, v52, v47
    v_and_b32 v61, v52, v48
    v_add_f32 v32, v32, v33
    v_add_f32 v34, v34, v35
    v_mfma_f32_16x16x16_bf16 v[36:39], v[80:81], v[54:55], v[36:39]
    v_mfma_f32_16x16x16_bf16 v[40:43], v[82:83], v[54:55], v[40:43]
    v_add_f32 v46, v46, v32
    v_mfma_f32_16x16x16_bf16 v[36:39], v[84:85], v[56:57], v[36:39]
    v_mfma_f32_16x16x16_bf16 v[40:43], v[86:87], v[56:57], v[40:43]
    v_add_f32 v46, v46, v34
    v_mfma_f32_16x16x16_bf16 v[36:39], v[88:89], v[58:59], v[36:39]
    v_mfma_f32_16x16x16_bf16 v[40:43], v[90:91], v[58:59], v[40:43]
    v_mfma_f32_16x16x16_bf16 v[36:39], v[92:93], v[60:61], v[36:39]
    v_mfma_f32_16x16x16_bf16 v[40:43], v[94:95], v[60:61], v[40:43]
    v_mfma_f32_16x16x32_bf16 v[32:35], v[96:99], v[16:19], 0
    v_mfma_f32_16x16x32_bf16 v[32:35], v[100:103], v[20:23], v[32:35]
    v_mfma_f32_16x16x32_bf16 v[32:35], v[104:107], v[24:27], v[32:35]
    v_mfma_f32_16x16x32_bf16 v[32:35], v[108:111], v[28:31], v[32:35]
    s_nop 7
    v_max3_f32 v49, v32, v33, v34
    v_max_f32 v49, v49, v35
    v_cmp_gt_f32 vcc, v49, v44
    s_cbranch_vccz L_skip1
    v_mov_b32 v50, v49
    s_nop 1
    v_permlane32_swap_b32 v50, v49
    v_max_f32 v49, v49, v50
    v_mov_b32 v50, v49
    s_nop 1
    v_permlane16_swap_b32 v50, v49
    v_max_f32 v49, v49, v50
    v_max_f32 v49, v49, v44
    v_sub_f32 v50, v44, v49
    v_mul_f32 v50, s44, v50
    v_exp_f32 v50, v50
    v_mov_b32 v44, v49
    v_mul_f32 v45, s44, v49
    v_mul_f32 v46, v46, v50
    v_mul_f32 v36, v36, v50
    v_mul_f32 v37, v37, v50
    v_mul_f32 v38, v38, v50
    v_mul_f32 v39, v39, v50
    v_mul_f32 v40, v40, v50
    v_mul_f32 v41, v41, v50
    v_mul_f32 v42, v42, v50
    v_mul_f32 v43, v43, v50
L_skip1:
    v_fma_f32 v32, v32, s44, -v45
    v_fma_f32 v33, v33, s44, -v45
    v_fma_f32 v34, v34, s44, -v45
    v_fma_f32 v35, v35, s44, -v45
    v_exp_f32 v32, v32
    v_exp_f32 v33, v33
    v_exp_f32 v34, v34
    v_exp_f32 v35, v35
    v_cvt_pk_bf16_f32 v49, v32, v32
    v_cvt_pk_bf16_f32 v50, v33, v33
    v_cvt_pk_bf16_f32 v51, v34, v34
    v_cvt_pk_bf16_f32 v52, v35, v35
    v_and_b32 v54, v49, v47
    v_and_b32 v55, v49, v48
    v_and_b32 v56, v50, v47
    v_and_b32 v57, v50, v48
    v_and_b32 v58, v51, v47
    v_and_b32 v59, v51, v48
    v_and_b32 v60, v52, v47
    v_and_b32 v61, v52, v48
    v_add_f32 v32, v32, v33
    v_add_f32 v34, v34, v35
    v_mfma_f32_16x16x16_bf16 v[36:39], v[112:113], v[54:55], v[36:39]
    v_mfma_f32_16x16x16_bf16 v[40:43], v[114:115], v[54:55], v[40:43]
    v_add_f32 v46, v46, v32
    v_mfma_f32_16x16x16_bf16 v[36:39], v[116:117], v[56:57], v[36:39]
    v_mfma_f32_16x16x16_bf16 v[40:43], v[118:119], v[56:57], v[40:43]
    v_add_f32 v46, v46, v34
    v_mfma_f32_16x16x16_bf16 v[36:39], v[120:121], v[58:59], v[36:39]
    v_mfma_f32_16x16x16_bf16 v[40:43], v[122:123], v[58:59], v[40:43]
    v_mfma_f32_16x16x16_bf16 v[36:39], v[124:125], v[60:61], v[36:39]
    v_mfma_f32_16x16x16_bf16 v[40:43], v[126:127], v[60:61], v[40:43]
    v_mfma_f32_16x16x32_bf16 v[32:35], v[128:131], v[16:19], 0
    v_mfma_f32_16x16x32_bf16 v[32:35], v[132:135], v[20:23], v[32:35]
    v_mfma_f32_16x16x32_bf16 v[32:35], v[136:139], v[24:27], v[32:35]
    v_mfma_f32_16x16x32_bf16 v[32:35], v[140:143], v[28:31], v[32:35]
    s_nop 7
    v_max3_f32 v49, v32, v33, v34
    v_max_f32 v49, v49, v35
    v_cmp_gt_f32 vcc, v49, v44
    s_cbranch_vccz L_skip2
    v_mov_b32 v50, v49
    s_nop 1
    v_permlane32_swap_b32 v50, v49
    v_max_f32 v49, v49, v50
    v_mov_b32 v50, v49
    s_nop 1
    v_permlane16_swap_b32 v50, v49
    v_max_f32 v49, v49, v50
    v_max_f32 v49, v49, v44
    v_sub_f32 v50, v44, v49
    v_mul_f32 v50, s44, v50
    v_exp_f32 v50, v50
    v_mov_b32 v44, v49
    v_mul_f32 v45, s44, v49
    v_mul_f32 v46, v46, v50
    v_mul_f32 v36, v36, v50
    v_mul_f32 v37, v37, v50
    v_mul_f32 v38, v38, v50
    v_mul_f32 v39, v39, v50
    v_mul_f32 v40, v40, v50
    v_mul_f32 v41, v41, v50
    v_mul_f32 v42, v42, v50
    v_mul_f32 v43, v43, v50
L_skip2:
    v_fma_f32 v32, v32, s44, -v45
    v_fma_f32 v33, v33, s44, -v45
    v_fma_f32 v34, v34, s44, -v45
    v_fma_f32 v35, v35, s44, -v45
    v_exp_f32 v32, v32
    v_exp_f32 v33, v33
    v_exp_f32 v34, v34
    v_exp_f32 v35, v35
    v_cvt_pk_bf16_f32 v49, v32, v32
    v_cvt_pk_bf16_f32 v50, v33, v33
    v_cvt_pk_bf16_f32 v51, v34, v34
    v_cvt_pk_bf16_f32 v52, v35, v35
    v_and_b32 v54, v49, v47
    v_and_b32 v55, v49, v48
    v_and_b32 v56, v50, v47
    v_and_b32 v57, v50, v48
    v_and_b32 v58, v51, v47
    v_and_b32 v59, v51, v48
    v_and_b32 v60, v52, v47
    v_and_b32 v61, v52, v48
    v_add_f32 v32, v32, v33
    v_add_f32 v34, v34, v35
    v_mfma_f32_16x16x16_bf16 v[36:39], v[144:145], v[54:55], v[36:39]
    v_mfma_f32_16x16x16_bf16 v[40:43], v[146:147], v[54:55], v[40:43]
    v_add_f32 v46, v46, v32
    v_mfma_f32_16x16x16_bf16 v[36:39], v[148:149], v[56:57], v[36:39]
    v_mfma_f32_16x16x16_bf16 v[40:43], v[150:151], v[56:57], v[40:43]
    v_add_f32 v46, v46, v34
    v_mfma_f32_16x16x16_bf16 v[36:39], v[152:153], v[58:59], v[36:39]
    v_mfma_f32_16x16x16_bf16 v[40:43], v[154:155], v[58:59], v[40:43]
    v_mfma_f32_16x16x16_bf16 v[36:39], v[156:157], v[60:61], v[36:39]
    v_mfma_f32_16x16x16_bf16 v[40:43], v[158:159], v[60:61], v[40:43]
    v_mfma_f32_16x16x32_bf16 v[32:35], v[160:163], v[16:19], 0
    v_mfma_f32_16x16x32_bf16 v[32:35], v[164:167], v[20:23], v[32:35]
    v_mfma_f32_16x16x32_bf16 v[32:35], v[168:171], v[24:27], v[32:35]
    v_mfma_f32_16x16x32_bf16 v[32:35], v[172:175], v[28:31], v[32:35]
    s_nop 7
    v_max3_f32 v49, v32, v33, v34
    v_max_f32 v49, v49, v35
    v_cmp_gt_f32 vcc, v49, v44
    s_cbranch_vccz L_skip3
    v_mov_b32 v50, v49
    s_nop 1
    v_permlane32_swap_b32 v50, v49
    v_max_f32 v49, v49, v50
    v_mov_b32 v50, v49
    s_nop 1
    v_permlane16_swap_b32 v50, v49
    v_max_f32 v49, v49, v50
    v_max_f32 v49, v49, v44
    v_sub_f32 v50, v44, v49
    v_mul_f32 v50, s44, v50
    v_exp_f32 v50, v50
    v_mov_b32 v44, v49
    v_mul_f32 v45, s44, v49
    v_mul_f32 v46, v46, v50
    v_mul_f32 v36, v36, v50
    v_mul_f32 v37, v37, v50
    v_mul_f32 v38, v38, v50
    v_mul_f32 v39, v39, v50
    v_mul_f32 v40, v40, v50
    v_mul_f32 v41, v41, v50
    v_mul_f32 v42, v42, v50
    v_mul_f32 v43, v43, v50
L_skip3:
    v_fma_f32 v32, v32, s44, -v45
    v_fma_f32 v33, v33, s44, -v45
    v_fma_f32 v34, v34, s44, -v45
    v_fma_f32 v35, v35, s44, -v45
    v_exp_f32 v32, v32
    v_exp_f32 v33, v33
    v_exp_f32 v34, v34
    v_exp_f32 v35, v35
    v_cvt_pk_bf16_f32 v49, v32, v32
    v_cvt_pk_bf16_f32 v50, v33, v33
    v_cvt_pk_bf16_f32 v51, v34, v34
    v_cvt_pk_bf16_f32 v52, v35, v35
    v_and_b32 v54, v49, v47
    v_and_b32 v55, v49, v48
    v_and_b32 v56, v50, v47
    v_and_b32 v57, v50, v48
    v_and_b32 v58, v51, v47
    v_and_b32 v59, v51, v48
    v_and_b32 v60, v52, v47
    v_and_b32 v61, v52, v48
    v_add_f32 v32, v32, v33
    v_add_f32 v34, v34, v35
    v_mfma_f32_16x16x16_bf16 v[36:39], v[176:177], v[54:55], v[36:39]
    v_mfma_f32_16x16x16_bf16 v[40:43], v[178:179], v[54:55], v[40:43]
    v_add_f32 v46, v46, v32
    v_mfma_f32_16x16x16_bf16 v[36:39], v[180:181], v[56:57], v[36:39]
    v_mfma_f32_16x16x16_bf16 v[40:43], v[182:183], v[56:57], v[40:43]
    v_add_f32 v46, v46, v34
    v_mfma_f32_16x16x16_bf16 v[36:39], v[184:185], v[58:59], v[36:39]
    v_mfma_f32_16x16x16_bf16 v[40:43], v[186:187], v[58:59], v[40:43]
    v_mfma_f32_16x16x16_bf16 v[36:39], v[188:189], v[60:61], v[36:39]
    v_mfma_f32_16x16x16_bf16 v[40:43], v[190:191], v[60:61], v[40:43]
    s_branch L_resume
L_sw4:
    s_cmp_lg_u32 s56, 0
    s_cbranch_scc1 L_swd4
    s_mov_b32 s41, 800000
L_sws4:
    ds_read_b64 v[62:63], v13 offset:4
    s_waitcnt lgkmcnt(0)
    v_readfirstlane_b32 s56, v63
    v_readfirstlane_b32 s57, v62
    s_cmp_lg_u32 s56, 0
    s_cbranch_scc1 L_swd4
    s_sleep 1
    s_sub_u32 s41, s41, 1
    s_cbranch_scc0 L_sws4
L_swd4:
    s_add_u32 s41, s52, s57
    s_lshr_b32 s58, s41, 4
    s_and_b32 s41, s41, 15
    s_mul_i32 s48, s58, 131
    s_add_u32 s48, s48, 17
    s_sub_u32 s59, s58, 13
    s_min_u32 s59, s59, 2
    s_add_u32 s48, s48, s59
    s_mul_i32 s59, s58, 124
    s_add_u32 s59, s59, 108
    s_cmp_lt_u32 s58, 14
    s_cselect_b32 s48, s59, s48
    s_add_u32 s48, s48, s41
    s_lshl_b32 s48, s48, 12
    s_cmp_lt_u32 s52, s56
    s_cselect_b32 s48, s48, s53
    s_branch L_swr4
L_sw5:
    s_cmp_lg_u32 s56, 0
    s_cbranch_scc1 L_swd5
    s_mov_b32 s41, 800000
L_sws5:
    ds_read_b64 v[62:63], v13 offset:4
    s_waitcnt lgkmcnt(0)
    v_readfirstlane_b32 s56, v63
    v_readfirstlane_b32 s57, v62
    s_cmp_lg_u32 s56, 0
    s_cbranch_scc1 L_swd5
    s_sleep 1
    s_sub_u32 s41, s41, 1
    s_cbranch_scc0 L_sws5
L_swd5:
    s_add_u32 s41, s52, s57
    s_lshr_b32 s58, s41, 4
    s_and_b32 s41, s41, 15
    s_mul_i32 s49, s58, 131
    s_add_u32 s49, s49, 17
    s_sub_u32 s59, s58, 13
    s_min_u32 s59, s59, 2
    s_add_u32 s49, s49, s59
    s_mul_i32 s59, s58, 124
    s_add_u32 s59, s59, 108
    s_cmp_lt_u32 s58, 14
    s_cselect_b32 s49, s59, s49
    s_add_u32 s49, s49, s41
    s_lshl_b32 s49, s49, 12
    s_cmp_lt_u32 s52, s56
    s_cselect_b32 s49, s49, s53
    s_branch L_swr5
.section .rodata,"a"
.p2align 6
.amdhsa_kernel recurrent_scan__gqa_block_cached__dense_activation_relu__decode_kernel
  .amdhsa_next_free_vgpr 256
  .amdhsa_next_free_sgpr 96
  .amdhsa_accum_offset 256
  .amdhsa_group_segment_fixed_size 0
  .amdhsa_kernarg_size 88
  .amdhsa_user_sgpr_count 2
  .amdhsa_user_sgpr_kernarg_segment_ptr 1
  .amdhsa_system_sgpr_workgroup_id_x 1
.end_amdhsa_kernel
```
